```python
import torch

def _softmax(x, axis=-1):
    return torch.softmax(x, dim=axis)
def _gelu(x):
    return torch.nn.functional.gelu(x, approximate="tanh")
def _silu(x):
    return torch.nn.functional.silu(x)
def _sigmoid(x):
    return torch.sigmoid(x)
def _layernorm(x, axis=-1, eps=1e-5):
    m = x.mean(dim=axis, keepdim=True)
    v = x.var(dim=axis, keepdim=True, unbiased=False)
    return (x - m) / torch.sqrt(v + eps)
def _scatter_add(tgt, idx, src, axis=0):
    return tgt.clone().index_add_(axis, idx, src)
def _segment_sum(src, seg, n):
    out = torch.zeros((n,) + src.shape[1:], dtype=src.dtype)
    return out.index_add_(0, seg, src)
def _pad(x, pw):
    flat = tuple(v for pair in reversed(pw) for v in pair)
    return torch.nn.functional.pad(x, flat)

kernel_name = 'standalone__edge_featured_mpnn_gatedgcn__graph'

def setup_inputs():

    _w = (lambda a: (lambda t: t.to(torch.bfloat16) if t.is_floating_point() else t)(torch.as_tensor(a)))
    N, deg, D, De = 25000, 16, 128, max(4, 1)
    E = N * deg
    return {
        "x": _w((lambda *s: torch.randn(*s, dtype=torch.bfloat16) * 0.4)(N, D)),
        "e_attr": _w((lambda *s: torch.randn(*s, dtype=torch.bfloat16) * 0.8)(E, De)),
        "src": _w((lambda lo, hi, *s: torch.randint(lo, hi, s))(0, N, E).to(torch.int64)),
        "dst": _w((lambda lo, hi, *s: torch.randint(lo, hi, s))(0, N, E).to(torch.int64)),
        "w_a": _w((lambda *s: torch.randn(*s, dtype=torch.bfloat16) * 0.4)(D, D)),
        "w_b": _w((lambda *s: torch.randn(*s, dtype=torch.bfloat16) * 0.4)(D, D)),
        "w_c": _w((lambda *s: torch.randn(*s, dtype=torch.bfloat16) * 0.8)(De, D)),
        "w_u": _w((lambda *s: torch.randn(*s, dtype=torch.bfloat16) * 0.05)(D, D)),
        "w_v": _w((lambda *s: torch.randn(*s, dtype=torch.bfloat16) * 0.05)(D, D)),
    }

def reference(x, e_attr, src, dst, w_a, w_b, w_c, w_u, w_v):
    N, D = x.shape
    hv = x @ w_v
    g = x[dst] @ w_a + x[src] @ w_b + e_attr @ w_c
    eta = _sigmoid(g)
    denom = _segment_sum(eta, dst, N) + 1e-6
    eta_n = eta / denom[dst]
    agg = _segment_sum(eta_n * hv[src], dst, N)
    z = x @ w_u + agg
    relu_z = torch.where(z > 0, z, 0 * z)
    return x + relu_z
```

```asm
; @launch kernel=kf_kernel grid=(256,1,1) block=(1024,1,1) lds=163840
.amdgcn_target "amdgcn-amd-amdhsa--gfx950"
.text
.globl kf_kernel
.p2align 8
.type kf_kernel,@function
kf_kernel:
    s_load_dwordx16 s[4:19], s[0:1], 0
    s_load_dwordx8 s[20:27], s[0:1], 64
    s_cmp_ge_u32 s2, 256
    s_cbranch_scc1 kf_exit
    v_lshrrev_b32 v1, 6, v0
    s_nop 0
    v_readfirstlane_b32 s3, v1
    v_and_b32 v1, 63, v0
    v_mov_b32 v3, 0
    v_lshlrev_b32 v25, 2, v0
    ds_write_b32 v25, v3
    s_mov_b32 s99, s2
    s_and_b32 s28, s2, 1
    s_bfe_u32 s29, s2, 0x20001
    s_lshl_b32 s29, s29, 5
    s_lshr_b32 s30, s2, 3
    s_add_u32 s29, s29, s30
    s_mul_i32 s30, s28, 6424576
    s_lshl_b32 s94, s28, 7
    s_cmp_gt_u32 s3, 7
    s_cbranch_scc1 kf_rec
    v_lshrrev_b32 v7, 4, v1
    v_lshrrev_b32 v9, 5, v1
    v_and_b32 v10, 1, v7
    v_lshl_or_b32 v10, v10, 1, v9
    v_lshlrev_b32 v10, 1, v10
    v_and_b32 v11, 7, v1
    v_xor_b32 v10, v10, v11
    v_lshlrev_b32 v10, 4, v10
    v_lshl_or_b32 v10, v9, 11, v10
    v_bfe_u32 v11, v1, 3, 2
    v_lshl_or_b32 v11, v11, 8, v10
    v_and_b32 v2, 15, v1
    v_mov_b32 v14, 1
    s_lshl_b32 s65, s3, 12
    s_add_u32 s65, s65, s94
    s_lshl_b32 s66, s28, 2
    s_xor_b32 s64, s3, s66
    s_lshl_b32 s64, s64, 11
    s_add_u32 s64, s64, 21504
    s_xor_b32 s67, s66, 7
    s_lshl_b32 s67, s67, 11
    s_add_u32 s67, s67, 21504
    s_add_u32 s66, s94, 28672
    v_mov_b32 v16, 0
    v_mov_b32 v17, 0
    v_mov_b32 v18, 0
    v_mov_b32 v19, 0
    v_lshlrev_b32 v20, 4, v1
    s_and_b32 s91, s2, 7
    s_lshl_b32 s91, s91, 5
    s_lshr_b32 s52, s2, 3
    s_or_b32 s91, s91, s52
    s_lshl_b32 s52, s91, 12
    s_add_u32 s52, s52, 17666048
    s_waitcnt lgkmcnt(0)
    s_mov_b32 s32, s26
    s_and_b32 s33, s27, 0xffff
    s_mov_b32 s34, 17829888
    s_mov_b32 s35, 0x00020000
    s_cmp_lg_u32 s3, 7
    s_cbranch_scc1 kf_g0
    s_setprio 3
    s_lshr_b32 s53, s2, 3
    s_lshl_b32 s53, s53, 10
    s_add_u32 s53, s53, s94
    v_lshlrev_b32 v21, 8, v1
    s_mov_b64 exec, 15
    s_mov_b32 s48, s14
    s_and_b32 s49, s15, 0xffff
    s_mov_b32 s50, 32768
    s_mov_b32 s51, 0x00020000
    buffer_load_dword v22, v21, s[48:51], s53 offen
    s_mov_b32 s48, s20
    s_and_b32 s49, s21, 0xffff
    s_mov_b32 s50, 32768
    s_mov_b32 s51, 0x00020000
    buffer_load_dword v22, v21, s[48:51], s53 offen
    s_mov_b32 s48, s12
    s_and_b32 s49, s13, 0xffff
    s_mov_b32 s50, 32768
    s_mov_b32 s51, 0x00020000
    buffer_load_dword v22, v21, s[48:51], s53 offen
    s_mov_b32 s48, s18
    s_and_b32 s49, s19, 0xffff
    s_mov_b32 s50, 32768
    s_mov_b32 s51, 0x00020000
    buffer_load_dword v22, v21, s[48:51], s53 offen
    s_mov_b64 exec, -1
    s_cmp_ge_u32 s91, 32
    s_cbranch_scc1 kf_g0
    buffer_store_dwordx4 v[16:19], v20, s[32:35], s52 offen offset:0 sc1
    buffer_store_dwordx4 v[16:19], v20, s[32:35], s52 offen offset:1024 sc1
    buffer_store_dwordx4 v[16:19], v20, s[32:35], s52 offen offset:2048 sc1
    buffer_store_dwordx4 v[16:19], v20, s[32:35], s52 offen offset:3072 sc1
    v_lshlrev_b32 v20, 7, v1
    s_lshl_b32 s52, s91, 10
    s_add_u32 s52, s52, 17797120
    s_mov_b64 exec, 0xff
    buffer_store_dword v16, v20, s[32:35], s52 offen sc1
    s_mov_b64 exec, -1
kf_g0:
    s_setprio 3
    s_barrier
    s_cmp_eq_u32 s3, 7
    s_cbranch_scc1 kf_plan
    s_mov_b32 s48, s14
    s_and_b32 s49, s15, 0xffff
    s_mov_b32 s50, 32768
    s_mov_b32 s51, 0x00020000
    s_add_u32 m0, s64, 0
    s_nop 0
    buffer_load_dwordx4 v11, s[48:51], s65 offen lds
    buffer_load_dwordx4 v11, s[48:51], s65 offen offset:1024 lds
    s_cmp_lg_u32 s3, 0
    s_cbranch_scc1 kf_w0
    s_add_u32 m0, s67, 0
    s_nop 0
    buffer_load_dwordx4 v11, s[48:51], s66 offen lds
    buffer_load_dwordx4 v11, s[48:51], s66 offen offset:1024 lds
kf_w0:
    s_mov_b32 s48, s20
    s_and_b32 s49, s21, 0xffff
    s_mov_b32 s50, 32768
    s_mov_b32 s51, 0x00020000
    s_add_u32 m0, s64, 16384
    s_nop 0
    buffer_load_dwordx4 v11, s[48:51], s65 offen lds
    buffer_load_dwordx4 v11, s[48:51], s65 offen offset:1024 lds
    s_cmp_lg_u32 s3, 1
    s_cbranch_scc1 kf_w1
    s_add_u32 m0, s67, 16384
    s_nop 0
    buffer_load_dwordx4 v11, s[48:51], s66 offen lds
    buffer_load_dwordx4 v11, s[48:51], s66 offen offset:1024 lds
kf_w1:
    s_mov_b32 s48, s12
    s_and_b32 s49, s13, 0xffff
    s_mov_b32 s50, 32768
    s_mov_b32 s51, 0x00020000
    s_add_u32 m0, s64, 32768
    s_nop 0
    buffer_load_dwordx4 v11, s[48:51], s65 offen lds
    buffer_load_dwordx4 v11, s[48:51], s65 offen offset:1024 lds
    s_cmp_lg_u32 s3, 2
    s_cbranch_scc1 kf_w2
    s_add_u32 m0, s67, 32768
    s_nop 0
    buffer_load_dwordx4 v11, s[48:51], s66 offen lds
    buffer_load_dwordx4 v11, s[48:51], s66 offen offset:1024 lds
kf_w2:
    s_mov_b32 s48, s18
    s_and_b32 s49, s19, 0xffff
    s_mov_b32 s50, 32768
    s_mov_b32 s51, 0x00020000
    s_add_u32 m0, s64, 49152
    s_nop 0
    buffer_load_dwordx4 v11, s[48:51], s65 offen lds
    buffer_load_dwordx4 v11, s[48:51], s65 offen offset:1024 lds
    s_cmp_lg_u32 s3, 3
    s_cbranch_scc1 kf_w3
    s_add_u32 m0, s67, 49152
    s_nop 0
    buffer_load_dwordx4 v11, s[48:51], s66 offen lds
    buffer_load_dwordx4 v11, s[48:51], s66 offen offset:1024 lds
kf_w3:
    v_and_b32 v9, 7, v2
    v_lshlrev_b32 v6, 8, v9
    v_lshl_add_u32 v6, v7, 4, v6
    v_lshrrev_b32 v12, 3, v2
    v_lshl_add_u32 v6, v12, 6, v6
    v_or_b32 v6, s94, v6
    v_xor_b32 v5, 128, v6
    s_mul_i32 s62, s29, 50176
    s_add_u32 s58, s62, 50176
    s_min_u32 s58, s58, 6400000
    s_lshl_b32 s63, s3, 13
    s_add_u32 s62, s62, s63
    s_add_u32 s63, s62, 0x1000
    s_mov_b32 s56, s4
    s_and_b32 s57, s5, 0xffff
    s_mov_b32 s59, 0x00020000
    v_lshlrev_b32 v8, 7, v9
    v_lshl_add_u32 v8, v7, 4, v8
    v_lshl_add_u32 v8, v12, 6, v8
    v_xor_b32 v15, 1088, v8
    v_xor_b32 v9, v9, v7
    v_lshlrev_b32 v9, 4, v9
    v_lshl_add_u32 v9, v2, 7, v9
    s_lshl_b32 s60, s3, 12
    s_add_u32 s31, s60, 87040
    v_add_u32 v9, s31, v9
    v_xor_b32 v10, 64, v9
    s_mov_b32 s54, 0xbfb8aa3b
    s_mov_b32 s55, 0xbfb8aa3b
    s_mul_i32 s31, s29, 25088
    s_add_u32 s31, s31, s30
    s_add_u32 s61, s31, 3212288
    s_cmp_eq_u32 s3, 6
    s_cselect_b32 s68, 0x00ff00ff, -1
    s_cselect_b32 s70, 0, -1
    s_mov_b32 s69, s68
    s_mov_b32 s71, s70
    s_add_u32 s44, s26, s31
    s_addc_u32 s45, s27, 0
    s_and_b32 s45, s45, 0xffff
    s_mov_b32 s46, 25088
    s_mov_b32 s47, 0x00020000
    s_add_u32 s40, s26, s61
    s_addc_u32 s41, s27, 0
    s_and_b32 s41, s41, 0xffff
    s_mov_b32 s42, 25088
    s_mov_b32 s43, 0x00020000
    s_waitcnt vmcnt(0)
    s_mov_b64 exec, 1
    ds_add_u32 v3, v14 offset:1552
    s_mov_b64 exec, -1
    s_setprio 0
    s_cmp_lt_u32 s3, 3
    s_cbranch_scc1 kf_xw
kf_xh:
    ds_read_b32 v4, v3 offset:1576
    s_waitcnt lgkmcnt(0)
    v_readfirstlane_b32 s53, v4
    s_cmp_ge_u32 s53, 8
    s_cbranch_scc1 kf_xh_ok
    s_sleep 1
    s_branch kf_xh
kf_xh_ok:
kf_xw:
    buffer_load_dwordx4 v[16:19], v6, s[56:59], s62 offen offset:0
    buffer_load_dwordx4 v[24:27], v5, s[56:59], s62 offen offset:0
    buffer_load_dwordx4 v[20:23], v6, s[56:59], s62 offen offset:2048
    buffer_load_dwordx4 v[28:31], v5, s[56:59], s62 offen offset:2048
    buffer_load_dwordx4 v[32:35], v6, s[56:59], s63 offen offset:0
    buffer_load_dwordx4 v[40:43], v5, s[56:59], s63 offen offset:0
    buffer_load_dwordx4 v[36:39], v6, s[56:59], s63 offen offset:2048
    buffer_load_dwordx4 v[44:47], v5, s[56:59], s63 offen offset:2048
    v_and_b32 v13, 1, v7
    v_lshl_or_b32 v12, v12, 1, v13
    v_lshlrev_b32 v12, 5, v12
    v_lshrrev_b32 v4, 2, v2
    v_lshl_or_b32 v4, v13, 2, v4
    v_lshl_or_b32 v12, v4, 7, v12
    v_and_b32 v4, 3, v2
    v_lshl_or_b32 v12, v4, 3, v12
    v_lshrrev_b32 v4, 1, v7
    v_lshl_or_b32 v12, v4, 11, v12
    v_add_u32 v12, 21504, v12
    v_xor_b32 v13, 32, v12
    v_xor_b32 v5, 64, v12
    v_xor_b32 v11, 96, v12
kf_sw:
    ds_read_b32 v4, v3 offset:1552
    s_waitcnt lgkmcnt(0)
    v_readfirstlane_b32 s53, v4
    s_cmp_ge_u32 s53, 7
    s_cbranch_scc1 kf_sw_ok
    s_sleep 1
    s_branch kf_sw
kf_sw_ok:
    ds_read_b64_tr_b16 v[112:113], v12 offset:32768
    ds_read_b64_tr_b16 v[114:115], v12 offset:33792
    ds_read_b64_tr_b16 v[116:117], v12 offset:36864
    ds_read_b64_tr_b16 v[118:119], v12 offset:37888
    ds_read_b64_tr_b16 v[120:121], v12 offset:40960
    ds_read_b64_tr_b16 v[122:123], v12 offset:41984
    s_waitcnt vmcnt(4)
    v_mov_b32 v96, v16
    v_mov_b32 v97, v17
    v_mov_b32 v98, v18
    v_mov_b32 v99, v19
    v_mov_b32_dpp v16, v20 row_ror:8 row_mask:0xf bank_mask:0xc
    v_mov_b32_dpp v17, v21 row_ror:8 row_mask:0xf bank_mask:0xc
    v_mov_b32_dpp v18, v22 row_ror:8 row_mask:0xf bank_mask:0xc
    v_mov_b32_dpp v19, v23 row_ror:8 row_mask:0xf bank_mask:0xc
    v_mov_b32_dpp v20, v96 row_ror:8 row_mask:0xf bank_mask:0x3
    v_mov_b32_dpp v21, v97 row_ror:8 row_mask:0xf bank_mask:0x3
    v_mov_b32_dpp v22, v98 row_ror:8 row_mask:0xf bank_mask:0x3
    v_mov_b32_dpp v23, v99 row_ror:8 row_mask:0xf bank_mask:0x3
    v_mov_b32 v100, v24
    v_mov_b32 v101, v25
    v_mov_b32 v102, v26
    v_mov_b32 v103, v27
    v_mov_b32_dpp v24, v28 row_ror:8 row_mask:0xf bank_mask:0xc
    v_mov_b32_dpp v25, v29 row_ror:8 row_mask:0xf bank_mask:0xc
    v_mov_b32_dpp v26, v30 row_ror:8 row_mask:0xf bank_mask:0xc
    v_mov_b32_dpp v27, v31 row_ror:8 row_mask:0xf bank_mask:0xc
    v_mov_b32_dpp v28, v100 row_ror:8 row_mask:0xf bank_mask:0x3
    v_mov_b32_dpp v29, v101 row_ror:8 row_mask:0xf bank_mask:0x3
    v_mov_b32_dpp v30, v102 row_ror:8 row_mask:0xf bank_mask:0x3
    v_mov_b32_dpp v31, v103 row_ror:8 row_mask:0xf bank_mask:0x3
    s_waitcnt vmcnt(0)
    v_mov_b32 v104, v32
    v_mov_b32 v105, v33
    v_mov_b32 v106, v34
    v_mov_b32 v107, v35
    v_mov_b32_dpp v32, v36 row_ror:8 row_mask:0xf bank_mask:0xc
    v_mov_b32_dpp v33, v37 row_ror:8 row_mask:0xf bank_mask:0xc
    v_mov_b32_dpp v34, v38 row_ror:8 row_mask:0xf bank_mask:0xc
    v_mov_b32_dpp v35, v39 row_ror:8 row_mask:0xf bank_mask:0xc
    v_mov_b32_dpp v36, v104 row_ror:8 row_mask:0xf bank_mask:0x3
    v_mov_b32_dpp v37, v105 row_ror:8 row_mask:0xf bank_mask:0x3
    v_mov_b32_dpp v38, v106 row_ror:8 row_mask:0xf bank_mask:0x3
    v_mov_b32_dpp v39, v107 row_ror:8 row_mask:0xf bank_mask:0x3
    v_mov_b32 v108, v40
    v_mov_b32 v109, v41
    v_mov_b32 v110, v42
    v_mov_b32 v111, v43
    v_mov_b32_dpp v40, v44 row_ror:8 row_mask:0xf bank_mask:0xc
    v_mov_b32_dpp v41, v45 row_ror:8 row_mask:0xf bank_mask:0xc
    v_mov_b32_dpp v42, v46 row_ror:8 row_mask:0xf bank_mask:0xc
    v_mov_b32_dpp v43, v47 row_ror:8 row_mask:0xf bank_mask:0xc
    v_mov_b32_dpp v44, v108 row_ror:8 row_mask:0xf bank_mask:0x3
    v_mov_b32_dpp v45, v109 row_ror:8 row_mask:0xf bank_mask:0x3
    v_mov_b32_dpp v46, v110 row_ror:8 row_mask:0xf bank_mask:0x3
    v_mov_b32_dpp v47, v111 row_ror:8 row_mask:0xf bank_mask:0x3
    ds_read_b64_tr_b16 v[124:125], v12 offset:45056
    ds_read_b64_tr_b16 v[126:127], v12 offset:46080
    s_waitcnt lgkmcnt(6)
    v_mfma_f32_16x16x32_bf16 v[48:51], v[112:115], v[16:19], 0
    v_mfma_f32_16x16x32_bf16 v[52:55], v[112:115], v[32:35], 0
    ds_read_b64_tr_b16 v[112:113], v12 offset:49152
    ds_read_b64_tr_b16 v[114:115], v12 offset:50176
    s_waitcnt lgkmcnt(6)
    v_mfma_f32_16x16x32_bf16 v[48:51], v[116:119], v[20:23], v[48:51]
    v_mfma_f32_16x16x32_bf16 v[52:55], v[116:119], v[36:39], v[52:55]
    ds_read_b64_tr_b16 v[116:117], v12 offset:53248
    ds_read_b64_tr_b16 v[118:119], v12 offset:54272
    s_waitcnt lgkmcnt(6)
    v_mfma_f32_16x16x32_bf16 v[48:51], v[120:123], v[24:27], v[48:51]
    v_mfma_f32_16x16x32_bf16 v[52:55], v[120:123], v[40:43], v[52:55]
    ds_read_b64_tr_b16 v[120:121], v12 offset:57344
    ds_read_b64_tr_b16 v[122:123], v12 offset:58368
    s_waitcnt lgkmcnt(6)
    v_mfma_f32_16x16x32_bf16 v[48:51], v[124:127], v[28:31], v[48:51]
    v_mfma_f32_16x16x32_bf16 v[52:55], v[124:127], v[44:47], v[52:55]
    ds_read_b64_tr_b16 v[124:125], v12 offset:61440
    ds_read_b64_tr_b16 v[126:127], v12 offset:62464
    s_waitcnt lgkmcnt(6)
    v_mfma_f32_16x16x32_bf16 v[56:59], v[112:115], v[16:19], 0
    v_mfma_f32_16x16x32_bf16 v[60:63], v[112:115], v[32:35], 0
    ds_read_b64_tr_b16 v[112:113], v13 offset:32768
    ds_read_b64_tr_b16 v[114:115], v13 offset:33792
    s_waitcnt lgkmcnt(6)
    v_mfma_f32_16x16x32_bf16 v[56:59], v[116:119], v[20:23], v[56:59]
    v_mfma_f32_16x16x32_bf16 v[60:63], v[116:119], v[36:39], v[60:63]
    ds_read_b64_tr_b16 v[116:117], v13 offset:36864
    ds_read_b64_tr_b16 v[118:119], v13 offset:37888
    s_waitcnt lgkmcnt(6)
    v_mfma_f32_16x16x32_bf16 v[56:59], v[120:123], v[24:27], v[56:59]
    v_mfma_f32_16x16x32_bf16 v[60:63], v[120:123], v[40:43], v[60:63]
    ds_read_b64_tr_b16 v[120:121], v13 offset:40960
    ds_read_b64_tr_b16 v[122:123], v13 offset:41984
    s_waitcnt lgkmcnt(6)
    v_mfma_f32_16x16x32_bf16 v[56:59], v[124:127], v[28:31], v[56:59]
    v_mfma_f32_16x16x32_bf16 v[60:63], v[124:127], v[44:47], v[60:63]
    ds_read_b64_tr_b16 v[124:125], v13 offset:45056
    ds_read_b64_tr_b16 v[126:127], v13 offset:46080
    s_waitcnt lgkmcnt(6)
    v_mfma_f32_16x16x32_bf16 v[64:67], v[112:115], v[16:19], 0
    v_mfma_f32_16x16x32_bf16 v[68:71], v[112:115], v[32:35], 0
    ds_read_b64_tr_b16 v[112:113], v13 offset:49152
    ds_read_b64_tr_b16 v[114:115], v13 offset:50176
    s_waitcnt lgkmcnt(6)
    v_mfma_f32_16x16x32_bf16 v[64:67], v[116:119], v[20:23], v[64:67]
    v_pk_mul_f32 v[48:49], v[48:49], s[54:55]
    v_pk_mul_f32 v[50:51], v[50:51], s[54:55]
    v_cvt_pk_bf16_f32 v48, v48, v49
    v_mfma_f32_16x16x32_bf16 v[68:71], v[116:119], v[36:39], v[68:71]
    v_cvt_pk_bf16_f32 v49, v50, v51
    v_cvt_pk_bf16_f32 v50, v56, v57
    v_cvt_pk_bf16_f32 v51, v58, v59
    ds_read_b64_tr_b16 v[116:117], v13 offset:53248
    ds_read_b64_tr_b16 v[118:119], v13 offset:54272
    s_waitcnt lgkmcnt(6)
    v_mfma_f32_16x16x32_bf16 v[64:67], v[120:123], v[24:27], v[64:67]
    s_mov_b64 exec, s[68:69]
    ds_write_b128 v9, v[48:51] offset:0
    s_mov_b64 exec, -1
    v_pk_mul_f32 v[52:53], v[52:53], s[54:55]
    v_pk_mul_f32 v[54:55], v[54:55], s[54:55]
    v_mfma_f32_16x16x32_bf16 v[68:71], v[120:123], v[40:43], v[68:71]
    v_cvt_pk_bf16_f32 v52, v52, v53
    v_cvt_pk_bf16_f32 v53, v54, v55
    v_cvt_pk_bf16_f32 v54, v60, v61
    ds_read_b64_tr_b16 v[120:121], v13 offset:57344
    ds_read_b64_tr_b16 v[122:123], v13 offset:58368
    s_waitcnt lgkmcnt(7)
    v_mfma_f32_16x16x32_bf16 v[64:67], v[124:127], v[28:31], v[64:67]
    v_cvt_pk_bf16_f32 v55, v62, v63
    s_mov_b64 exec, s[70:71]
    ds_write_b128 v9, v[52:55] offset:2048
    s_mov_b64 exec, -1
    v_mfma_f32_16x16x32_bf16 v[68:71], v[124:127], v[44:47], v[68:71]
    ds_read_b64_tr_b16 v[124:125], v13 offset:61440
    ds_read_b64_tr_b16 v[126:127], v13 offset:62464
    s_waitcnt lgkmcnt(8)
    v_mfma_f32_16x16x32_bf16 v[72:75], v[112:115], v[16:19], 0
    v_mfma_f32_16x16x32_bf16 v[76:79], v[112:115], v[32:35], 0
    ds_read_b64_tr_b16 v[112:113], v5 offset:32768
    ds_read_b64_tr_b16 v[114:115], v5 offset:33792
    s_waitcnt lgkmcnt(8)
    v_mfma_f32_16x16x32_bf16 v[72:75], v[116:119], v[20:23], v[72:75]
    v_mfma_f32_16x16x32_bf16 v[76:79], v[116:119], v[36:39], v[76:79]
    ds_read_b64_tr_b16 v[116:117], v5 offset:36864
    ds_read_b64_tr_b16 v[118:119], v5 offset:37888
    s_waitcnt lgkmcnt(7)
    v_mfma_f32_16x16x32_bf16 v[72:75], v[120:123], v[24:27], v[72:75]
    v_mfma_f32_16x16x32_bf16 v[76:79], v[120:123], v[40:43], v[76:79]
    ds_read_b64_tr_b16 v[120:121], v5 offset:40960
    ds_read_b64_tr_b16 v[122:123], v5 offset:41984
    s_waitcnt lgkmcnt(6)
    v_mfma_f32_16x16x32_bf16 v[72:75], v[124:127], v[28:31], v[72:75]
    v_mfma_f32_16x16x32_bf16 v[76:79], v[124:127], v[44:47], v[76:79]
    ds_read_b64_tr_b16 v[124:125], v5 offset:45056
    ds_read_b64_tr_b16 v[126:127], v5 offset:46080
    s_waitcnt lgkmcnt(6)
    v_mfma_f32_16x16x32_bf16 v[80:83], v[112:115], v[16:19], 0
    v_mfma_f32_16x16x32_bf16 v[84:87], v[112:115], v[32:35], 0
    ds_read_b64_tr_b16 v[112:113], v5 offset:49152
    ds_read_b64_tr_b16 v[114:115], v5 offset:50176
    s_waitcnt lgkmcnt(6)
    v_mfma_f32_16x16x32_bf16 v[80:83], v[116:119], v[20:23], v[80:83]
    v_pk_mul_f32 v[64:65], v[64:65], s[54:55]
    v_pk_mul_f32 v[66:67], v[66:67], s[54:55]
    v_cvt_pk_bf16_f32 v64, v64, v65
    v_mfma_f32_16x16x32_bf16 v[84:87], v[116:119], v[36:39], v[84:87]
    v_cvt_pk_bf16_f32 v65, v66, v67
    v_cvt_pk_bf16_f32 v66, v72, v73
    v_cvt_pk_bf16_f32 v67, v74, v75
    ds_read_b64_tr_b16 v[116:117], v5 offset:53248
    ds_read_b64_tr_b16 v[118:119], v5 offset:54272
    s_waitcnt lgkmcnt(6)
    v_mfma_f32_16x16x32_bf16 v[80:83], v[120:123], v[24:27], v[80:83]
    s_mov_b64 exec, s[68:69]
    ds_write_b128 v10, v[64:67] offset:0
    s_mov_b64 exec, -1
    v_pk_mul_f32 v[68:69], v[68:69], s[54:55]
    v_pk_mul_f32 v[70:71], v[70:71], s[54:55]
    v_mfma_f32_16x16x32_bf16 v[84:87], v[120:123], v[40:43], v[84:87]
    v_cvt_pk_bf16_f32 v68, v68, v69
    v_cvt_pk_bf16_f32 v69, v70, v71
    v_cvt_pk_bf16_f32 v70, v76, v77
    ds_read_b64_tr_b16 v[120:121], v5 offset:57344
    ds_read_b64_tr_b16 v[122:123], v5 offset:58368
    s_waitcnt lgkmcnt(7)
    v_mfma_f32_16x16x32_bf16 v[80:83], v[124:127], v[28:31], v[80:83]
    v_cvt_pk_bf16_f32 v71, v78, v79
    s_mov_b64 exec, s[70:71]
    ds_write_b128 v10, v[68:71] offset:2048
    s_mov_b64 exec, -1
    v_mfma_f32_16x16x32_bf16 v[84:87], v[124:127], v[44:47], v[84:87]
    ds_read_b64_tr_b16 v[124:125], v5 offset:61440
    ds_read_b64_tr_b16 v[126:127], v5 offset:62464
    s_waitcnt lgkmcnt(8)
    v_mfma_f32_16x16x32_bf16 v[88:91], v[112:115], v[16:19], 0
    v_mfma_f32_16x16x32_bf16 v[92:95], v[112:115], v[32:35], 0
    ds_read_b64_tr_b16 v[112:113], v11 offset:32768
    ds_read_b64_tr_b16 v[114:115], v11 offset:33792
    s_waitcnt lgkmcnt(8)
    v_mfma_f32_16x16x32_bf16 v[88:91], v[116:119], v[20:23], v[88:91]
    v_mfma_f32_16x16x32_bf16 v[92:95], v[116:119], v[36:39], v[92:95]
    ds_read_b64_tr_b16 v[116:117], v11 offset:36864
    ds_read_b64_tr_b16 v[118:119], v11 offset:37888
    s_waitcnt lgkmcnt(7)
    v_mfma_f32_16x16x32_bf16 v[88:91], v[120:123], v[24:27], v[88:91]
    v_mfma_f32_16x16x32_bf16 v[92:95], v[120:123], v[40:43], v[92:95]
    ds_read_b64_tr_b16 v[120:121], v11 offset:40960
    ds_read_b64_tr_b16 v[122:123], v11 offset:41984
    s_waitcnt lgkmcnt(6)
    v_mfma_f32_16x16x32_bf16 v[88:91], v[124:127], v[28:31], v[88:91]
    v_mfma_f32_16x16x32_bf16 v[92:95], v[124:127], v[44:47], v[92:95]
    ds_read_b64_tr_b16 v[124:125], v11 offset:45056
    ds_read_b64_tr_b16 v[126:127], v11 offset:46080
    s_waitcnt lgkmcnt(6)
    v_mfma_f32_16x16x32_bf16 v[96:99], v[112:115], v[16:19], 0
    v_mfma_f32_16x16x32_bf16 v[100:103], v[112:115], v[32:35], 0
    ds_read_b64_tr_b16 v[112:113], v11 offset:49152
    ds_read_b64_tr_b16 v[114:115], v11 offset:50176
    s_waitcnt lgkmcnt(6)
    v_mfma_f32_16x16x32_bf16 v[96:99], v[116:119], v[20:23], v[96:99]
    v_pk_mul_f32 v[80:81], v[80:81], s[54:55]
    v_pk_mul_f32 v[82:83], v[82:83], s[54:55]
    v_cvt_pk_bf16_f32 v80, v80, v81
    v_mfma_f32_16x16x32_bf16 v[100:103], v[116:119], v[36:39], v[100:103]
    v_cvt_pk_bf16_f32 v81, v82, v83
    v_cvt_pk_bf16_f32 v82, v88, v89
    v_cvt_pk_bf16_f32 v83, v90, v91
    ds_read_b64_tr_b16 v[116:117], v11 offset:53248
    ds_read_b64_tr_b16 v[118:119], v11 offset:54272
    s_waitcnt lgkmcnt(6)
    v_mfma_f32_16x16x32_bf16 v[96:99], v[120:123], v[24:27], v[96:99]
    s_mov_b64 exec, s[68:69]
    ds_write_b128 v9, v[80:83] offset:25600
    s_mov_b64 exec, -1
    v_pk_mul_f32 v[84:85], v[84:85], s[54:55]
    v_pk_mul_f32 v[86:87], v[86:87], s[54:55]
    v_mfma_f32_16x16x32_bf16 v[100:103], v[120:123], v[40:43], v[100:103]
    v_cvt_pk_bf16_f32 v84, v84, v85
    v_cvt_pk_bf16_f32 v85, v86, v87
    v_cvt_pk_bf16_f32 v86, v92, v93
    ds_read_b64_tr_b16 v[120:121], v11 offset:57344
    ds_read_b64_tr_b16 v[122:123], v11 offset:58368
    s_waitcnt lgkmcnt(7)
    v_mfma_f32_16x16x32_bf16 v[96:99], v[124:127], v[28:31], v[96:99]
    v_cvt_pk_bf16_f32 v87, v94, v95
    s_mov_b64 exec, s[70:71]
    ds_write_b128 v9, v[84:87] offset:27648
    s_mov_b64 exec, -1
    v_mfma_f32_16x16x32_bf16 v[100:103], v[124:127], v[44:47], v[100:103]
    ds_read_b64_tr_b16 v[124:125], v11 offset:61440
    ds_read_b64_tr_b16 v[126:127], v11 offset:62464
    s_waitcnt lgkmcnt(8)
    v_mfma_f32_16x16x32_bf16 v[104:107], v[112:115], v[16:19], 0
    v_mfma_f32_16x16x32_bf16 v[108:111], v[112:115], v[32:35], 0
    ds_read_b64_tr_b16 v[112:113], v12 offset:0
    ds_read_b64_tr_b16 v[114:115], v12 offset:1024
    s_waitcnt lgkmcnt(8)
    v_mfma_f32_16x16x32_bf16 v[104:107], v[116:119], v[20:23], v[104:107]
    v_mfma_f32_16x16x32_bf16 v[108:111], v[116:119], v[36:39], v[108:111]
    ds_read_b64_tr_b16 v[116:117], v12 offset:4096
    ds_read_b64_tr_b16 v[118:119], v12 offset:5120
    s_waitcnt lgkmcnt(7)
    v_mfma_f32_16x16x32_bf16 v[104:107], v[120:123], v[24:27], v[104:107]
    v_mfma_f32_16x16x32_bf16 v[108:111], v[120:123], v[40:43], v[108:111]
    ds_read_b64_tr_b16 v[120:121], v12 offset:8192
    ds_read_b64_tr_b16 v[122:123], v12 offset:9216
    s_waitcnt lgkmcnt(6)
    v_mfma_f32_16x16x32_bf16 v[104:107], v[124:127], v[28:31], v[104:107]
    v_mfma_f32_16x16x32_bf16 v[108:111], v[124:127], v[44:47], v[108:111]
    ds_read_b64_tr_b16 v[124:125], v12 offset:12288
    ds_read_b64_tr_b16 v[126:127], v12 offset:13312
    s_waitcnt lgkmcnt(6)
    v_mfma_f32_16x16x32_bf16 v[48:51], v[112:115], v[16:19], 0
    v_mfma_f32_16x16x32_bf16 v[52:55], v[112:115], v[32:35], 0
    ds_read_b64_tr_b16 v[112:113], v12 offset:16384
    ds_read_b64_tr_b16 v[114:115], v12 offset:17408
    s_waitcnt lgkmcnt(6)
    v_mfma_f32_16x16x32_bf16 v[48:51], v[116:119], v[20:23], v[48:51]
    v_pk_mul_f32 v[96:97], v[96:97], s[54:55]
    v_pk_mul_f32 v[98:99], v[98:99], s[54:55]
    v_cvt_pk_bf16_f32 v96, v96, v97
    v_mfma_f32_16x16x32_bf16 v[52:55], v[116:119], v[36:39], v[52:55]
    v_cvt_pk_bf16_f32 v97, v98, v99
    v_cvt_pk_bf16_f32 v98, v104, v105
    v_cvt_pk_bf16_f32 v99, v106, v107
    ds_read_b64_tr_b16 v[116:117], v12 offset:20480
    ds_read_b64_tr_b16 v[118:119], v12 offset:21504
    s_waitcnt lgkmcnt(6)
    v_mfma_f32_16x16x32_bf16 v[48:51], v[120:123], v[24:27], v[48:51]
    s_mov_b64 exec, s[68:69]
    ds_write_b128 v10, v[96:99] offset:25600
    s_mov_b64 exec, -1
    v_pk_mul_f32 v[100:101], v[100:101], s[54:55]
    v_pk_mul_f32 v[102:103], v[102:103], s[54:55]
    v_mfma_f32_16x16x32_bf16 v[52:55], v[120:123], v[40:43], v[52:55]
    v_cvt_pk_bf16_f32 v100, v100, v101
    v_cvt_pk_bf16_f32 v101, v102, v103
    v_cvt_pk_bf16_f32 v102, v108, v109
    ds_read_b64_tr_b16 v[120:121], v12 offset:24576
    ds_read_b64_tr_b16 v[122:123], v12 offset:25600
    s_waitcnt lgkmcnt(7)
    v_mfma_f32_16x16x32_bf16 v[48:51], v[124:127], v[28:31], v[48:51]
    v_cvt_pk_bf16_f32 v103, v110, v111
    s_mov_b64 exec, s[70:71]
    ds_write_b128 v10, v[100:103] offset:27648
    s_mov_b64 exec, -1
    v_mfma_f32_16x16x32_bf16 v[52:55], v[124:127], v[44:47], v[52:55]
    ds_read_b64_tr_b16 v[124:125], v12 offset:28672
    ds_read_b64_tr_b16 v[126:127], v12 offset:29696
    s_waitcnt lgkmcnt(8)
    v_mfma_f32_16x16x32_bf16 v[56:59], v[112:115], v[16:19], 0
    v_mfma_f32_16x16x32_bf16 v[60:63], v[112:115], v[32:35], 0
    ds_read_b64_tr_b16 v[112:113], v13 offset:0
    ds_read_b64_tr_b16 v[114:115], v13 offset:1024
    s_waitcnt lgkmcnt(8)
    v_mfma_f32_16x16x32_bf16 v[56:59], v[116:119], v[20:23], v[56:59]
    v_mfma_f32_16x16x32_bf16 v[60:63], v[116:119], v[36:39], v[60:63]
    ds_read_b64_tr_b16 v[116:117], v13 offset:4096
    ds_read_b64_tr_b16 v[118:119], v13 offset:5120
    s_waitcnt lgkmcnt(7)
    v_mfma_f32_16x16x32_bf16 v[56:59], v[120:123], v[24:27], v[56:59]
    v_mfma_f32_16x16x32_bf16 v[60:63], v[120:123], v[40:43], v[60:63]
    ds_read_b64_tr_b16 v[120:121], v13 offset:8192
    ds_read_b64_tr_b16 v[122:123], v13 offset:9216
    s_waitcnt lgkmcnt(6)
    v_mfma_f32_16x16x32_bf16 v[56:59], v[124:127], v[28:31], v[56:59]
    v_mfma_f32_16x16x32_bf16 v[60:63], v[124:127], v[44:47], v[60:63]
    ds_read_b64_tr_b16 v[124:125], v13 offset:12288
    ds_read_b64_tr_b16 v[126:127], v13 offset:13312
    s_waitcnt lgkmcnt(6)
    v_mfma_f32_16x16x32_bf16 v[64:67], v[112:115], v[16:19], 0
    v_mfma_f32_16x16x32_bf16 v[68:71], v[112:115], v[32:35], 0
    ds_read_b64_tr_b16 v[112:113], v13 offset:16384
    ds_read_b64_tr_b16 v[114:115], v13 offset:17408
    s_waitcnt lgkmcnt(6)
    v_mfma_f32_16x16x32_bf16 v[64:67], v[116:119], v[20:23], v[64:67]
    v_pk_mul_f32 v[48:49], v[48:49], s[54:55]
    v_pk_mul_f32 v[50:51], v[50:51], s[54:55]
    v_cvt_pk_bf16_f32 v48, v48, v56
    v_mfma_f32_16x16x32_bf16 v[68:71], v[116:119], v[36:39], v[68:71]
    v_mov_b32 v56, v48
    v_cvt_pk_bf16_f32 v49, v49, v57
    v_mov_b32 v57, v49
    ds_read_b64_tr_b16 v[116:117], v13 offset:20480
    ds_read_b64_tr_b16 v[118:119], v13 offset:21504
    s_waitcnt lgkmcnt(6)
    v_mfma_f32_16x16x32_bf16 v[64:67], v[120:123], v[24:27], v[64:67]
    v_cvt_pk_bf16_f32 v50, v50, v58
    v_mov_b32 v58, v50
    v_cvt_pk_bf16_f32 v51, v51, v59
    v_mfma_f32_16x16x32_bf16 v[68:71], v[120:123], v[40:43], v[68:71]
    v_mov_b32 v59, v51
    v_pk_mul_f32 v[52:53], v[52:53], s[54:55]
    v_pk_mul_f32 v[54:55], v[54:55], s[54:55]
    ds_read_b64_tr_b16 v[120:121], v13 offset:24576
    ds_read_b64_tr_b16 v[122:123], v13 offset:25600
    s_waitcnt lgkmcnt(6)
    v_mfma_f32_16x16x32_bf16 v[64:67], v[124:127], v[28:31], v[64:67]
    v_cvt_pk_bf16_f32 v52, v52, v60
    v_mov_b32 v60, v52
    v_cvt_pk_bf16_f32 v53, v53, v61
    v_mfma_f32_16x16x32_bf16 v[68:71], v[124:127], v[44:47], v[68:71]
    v_mov_b32 v61, v53
    v_cvt_pk_bf16_f32 v54, v54, v62
    v_mov_b32 v62, v54
    ds_read_b64_tr_b16 v[124:125], v13 offset:28672
    ds_read_b64_tr_b16 v[126:127], v13 offset:29696
    s_waitcnt lgkmcnt(6)
    v_mfma_f32_16x16x32_bf16 v[72:75], v[112:115], v[16:19], 0
    v_cvt_pk_bf16_f32 v55, v55, v63
    v_mov_b32 v63, v55
    v_mfma_f32_16x16x32_bf16 v[76:79], v[112:115], v[32:35], 0
    ds_read_b64_tr_b16 v[112:113], v5 offset:0
    ds_read_b64_tr_b16 v[114:115], v5 offset:1024
    s_waitcnt lgkmcnt(6)
    v_mfma_f32_16x16x32_bf16 v[72:75], v[116:119], v[20:23], v[72:75]
    v_mfma_f32_16x16x32_bf16 v[76:79], v[116:119], v[36:39], v[76:79]
    ds_read_b64_tr_b16 v[116:117], v5 offset:4096
    ds_read_b64_tr_b16 v[118:119], v5 offset:5120
    s_waitcnt lgkmcnt(6)
    v_mfma_f32_16x16x32_bf16 v[72:75], v[120:123], v[24:27], v[72:75]
    v_mfma_f32_16x16x32_bf16 v[76:79], v[120:123], v[40:43], v[76:79]
    ds_read_b64_tr_b16 v[120:121], v5 offset:8192
    ds_read_b64_tr_b16 v[122:123], v5 offset:9216
    s_waitcnt lgkmcnt(6)
    v_mfma_f32_16x16x32_bf16 v[72:75], v[124:127], v[28:31], v[72:75]
    v_mfma_f32_16x16x32_bf16 v[76:79], v[124:127], v[44:47], v[76:79]
    ds_read_b64_tr_b16 v[124:125], v5 offset:12288
    ds_read_b64_tr_b16 v[126:127], v5 offset:13312
    s_waitcnt lgkmcnt(6)
    v_mfma_f32_16x16x32_bf16 v[80:83], v[112:115], v[16:19], 0
    v_mfma_f32_16x16x32_bf16 v[84:87], v[112:115], v[32:35], 0
    ds_read_b64_tr_b16 v[112:113], v5 offset:16384
    ds_read_b64_tr_b16 v[114:115], v5 offset:17408
    s_waitcnt lgkmcnt(6)
    v_mfma_f32_16x16x32_bf16 v[80:83], v[116:119], v[20:23], v[80:83]
    v_pk_mul_f32 v[64:65], v[64:65], s[54:55]
    v_pk_mul_f32 v[66:67], v[66:67], s[54:55]
    v_cvt_pk_bf16_f32 v64, v64, v72
    v_mfma_f32_16x16x32_bf16 v[84:87], v[116:119], v[36:39], v[84:87]
    v_cvt_pk_bf16_f32 v65, v65, v73
    v_cvt_pk_bf16_f32 v66, v66, v74
    v_cvt_pk_bf16_f32 v67, v67, v75
    ds_read_b64_tr_b16 v[116:117], v5 offset:20480
    ds_read_b64_tr_b16 v[118:119], v5 offset:21504
    s_waitcnt lgkmcnt(6)
    v_mfma_f32_16x16x32_bf16 v[80:83], v[120:123], v[24:27], v[80:83]
    v_mov_b32_dpp v48, v64 row_ror:8 row_mask:0xf bank_mask:0xc
    v_mov_b32_dpp v49, v65 row_ror:8 row_mask:0xf bank_mask:0xc
    v_mov_b32_dpp v50, v66 row_ror:8 row_mask:0xf bank_mask:0xc
    v_mfma_f32_16x16x32_bf16 v[84:87], v[120:123], v[40:43], v[84:87]
    v_mov_b32_dpp v51, v67 row_ror:8 row_mask:0xf bank_mask:0xc
    v_mov_b32_dpp v56, v64 row_ror:8 row_mask:0xf bank_mask:0x3
    v_mov_b32_dpp v57, v65 row_ror:8 row_mask:0xf bank_mask:0x3
    ds_read_b64_tr_b16 v[120:121], v5 offset:24576
    ds_read_b64_tr_b16 v[122:123], v5 offset:25600
    s_waitcnt lgkmcnt(6)
    v_mfma_f32_16x16x32_bf16 v[80:83], v[124:127], v[28:31], v[80:83]
    v_mov_b32_dpp v58, v66 row_ror:8 row_mask:0xf bank_mask:0x3
    v_mov_b32_dpp v59, v67 row_ror:8 row_mask:0xf bank_mask:0x3
    s_setprio 1
    buffer_store_dwordx4 v[48:51], v8, s[44:47], s60 offen offset:0 sc1
    s_setprio 0
    v_mfma_f32_16x16x32_bf16 v[84:87], v[124:127], v[44:47], v[84:87]
    s_setprio 1
    buffer_store_dwordx4 v[56:59], v15, s[44:47], s60 offen offset:0 sc1
    s_setprio 0
    ds_read_b64_tr_b16 v[124:125], v5 offset:28672
    ds_read_b64_tr_b16 v[126:127], v5 offset:29696
    s_waitcnt lgkmcnt(6)
    v_mfma_f32_16x16x32_bf16 v[88:91], v[112:115], v[16:19], 0
    v_pk_mul_f32 v[68:69], v[68:69], s[54:55]
    v_pk_mul_f32 v[70:71], v[70:71], s[54:55]
    v_cvt_pk_bf16_f32 v68, v68, v76
    v_mfma_f32_16x16x32_bf16 v[92:95], v[112:115], v[32:35], 0
    v_cvt_pk_bf16_f32 v69, v69, v77
    v_cvt_pk_bf16_f32 v70, v70, v78
    v_cvt_pk_bf16_f32 v71, v71, v79
    ds_read_b64_tr_b16 v[112:113], v11 offset:0
    ds_read_b64_tr_b16 v[114:115], v11 offset:1024
    s_waitcnt lgkmcnt(6)
    v_mfma_f32_16x16x32_bf16 v[88:91], v[116:119], v[20:23], v[88:91]
    v_mov_b32_dpp v52, v68 row_ror:8 row_mask:0xf bank_mask:0xc
    v_mov_b32_dpp v53, v69 row_ror:8 row_mask:0xf bank_mask:0xc
    v_mov_b32_dpp v54, v70 row_ror:8 row_mask:0xf bank_mask:0xc
    v_mfma_f32_16x16x32_bf16 v[92:95], v[116:119], v[36:39], v[92:95]
    v_mov_b32_dpp v55, v71 row_ror:8 row_mask:0xf bank_mask:0xc
    v_mov_b32_dpp v60, v68 row_ror:8 row_mask:0xf bank_mask:0x3
    v_mov_b32_dpp v61, v69 row_ror:8 row_mask:0xf bank_mask:0x3
    ds_read_b64_tr_b16 v[116:117], v11 offset:4096
    ds_read_b64_tr_b16 v[118:119], v11 offset:5120
    s_waitcnt lgkmcnt(6)
    v_mfma_f32_16x16x32_bf16 v[88:91], v[120:123], v[24:27], v[88:91]
    v_mov_b32_dpp v62, v70 row_ror:8 row_mask:0xf bank_mask:0x3
    v_mov_b32_dpp v63, v71 row_ror:8 row_mask:0xf bank_mask:0x3
    s_setprio 1
    buffer_store_dwordx4 v[52:55], v8, s[44:47], s60 offen offset:2048 sc1
    s_setprio 0
    v_mfma_f32_16x16x32_bf16 v[92:95], v[120:123], v[40:43], v[92:95]
    s_setprio 1
    buffer_store_dwordx4 v[60:63], v15, s[44:47], s60 offen offset:2048 sc1
    s_setprio 0
    ds_read_b64_tr_b16 v[120:121], v11 offset:8192
    ds_read_b64_tr_b16 v[122:123], v11 offset:9216
    s_waitcnt lgkmcnt(6)
    v_mfma_f32_16x16x32_bf16 v[88:91], v[124:127], v[28:31], v[88:91]
    v_mfma_f32_16x16x32_bf16 v[92:95], v[124:127], v[44:47], v[92:95]
    ds_read_b64_tr_b16 v[124:125], v11 offset:12288
    ds_read_b64_tr_b16 v[126:127], v11 offset:13312
    s_waitcnt lgkmcnt(6)
    v_mfma_f32_16x16x32_bf16 v[96:99], v[112:115], v[16:19], 0
    v_mfma_f32_16x16x32_bf16 v[100:103], v[112:115], v[32:35], 0
    ds_read_b64_tr_b16 v[112:113], v11 offset:16384
    ds_read_b64_tr_b16 v[114:115], v11 offset:17408
    s_waitcnt lgkmcnt(6)
    v_mfma_f32_16x16x32_bf16 v[96:99], v[116:119], v[20:23], v[96:99]
    v_pk_mul_f32 v[80:81], v[80:81], s[54:55]
    v_pk_mul_f32 v[82:83], v[82:83], s[54:55]
    v_cvt_pk_bf16_f32 v80, v80, v88
    v_mfma_f32_16x16x32_bf16 v[100:103], v[116:119], v[36:39], v[100:103]
    v_mov_b32 v88, v80
    v_cvt_pk_bf16_f32 v81, v81, v89
    v_mov_b32 v89, v81
    ds_read_b64_tr_b16 v[116:117], v11 offset:20480
    ds_read_b64_tr_b16 v[118:119], v11 offset:21504
    s_waitcnt lgkmcnt(6)
    v_mfma_f32_16x16x32_bf16 v[96:99], v[120:123], v[24:27], v[96:99]
    v_cvt_pk_bf16_f32 v82, v82, v90
    v_mov_b32 v90, v82
    v_cvt_pk_bf16_f32 v83, v83, v91
    v_mfma_f32_16x16x32_bf16 v[100:103], v[120:123], v[40:43], v[100:103]
    v_mov_b32 v91, v83
    v_pk_mul_f32 v[84:85], v[84:85], s[54:55]
    v_pk_mul_f32 v[86:87], v[86:87], s[54:55]
    ds_read_b64_tr_b16 v[120:121], v11 offset:24576
    ds_read_b64_tr_b16 v[122:123], v11 offset:25600
    s_waitcnt lgkmcnt(6)
    v_mfma_f32_16x16x32_bf16 v[96:99], v[124:127], v[28:31], v[96:99]
    v_cvt_pk_bf16_f32 v84, v84, v92
    v_mov_b32 v92, v84
    v_cvt_pk_bf16_f32 v85, v85, v93
    v_mfma_f32_16x16x32_bf16 v[100:103], v[124:127], v[44:47], v[100:103]
    v_mov_b32 v93, v85
    v_cvt_pk_bf16_f32 v86, v86, v94
    v_mov_b32 v94, v86
    ds_read_b64_tr_b16 v[124:125], v11 offset:28672
    ds_read_b64_tr_b16 v[126:127], v11 offset:29696
    s_waitcnt lgkmcnt(6)
    v_mfma_f32_16x16x32_bf16 v[104:107], v[112:115], v[16:19], 0
    v_cvt_pk_bf16_f32 v87, v87, v95
    v_mov_b32 v95, v87
    v_mfma_f32_16x16x32_bf16 v[108:111], v[112:115], v[32:35], 0
    s_waitcnt lgkmcnt(4)
    v_mfma_f32_16x16x32_bf16 v[104:107], v[116:119], v[20:23], v[104:107]
    v_mfma_f32_16x16x32_bf16 v[108:111], v[116:119], v[36:39], v[108:111]
    s_waitcnt lgkmcnt(2)
    v_mfma_f32_16x16x32_bf16 v[104:107], v[120:123], v[24:27], v[104:107]
    v_mfma_f32_16x16x32_bf16 v[108:111], v[120:123], v[40:43], v[108:111]
    s_waitcnt lgkmcnt(0)
    v_mfma_f32_16x16x32_bf16 v[104:107], v[124:127], v[28:31], v[104:107]
    v_mfma_f32_16x16x32_bf16 v[108:111], v[124:127], v[44:47], v[108:111]
    s_mov_b64 exec, 1
    ds_add_u32 v3, v14 offset:1580
    s_mov_b64 exec, -1
    v_pk_mul_f32 v[96:97], v[96:97], s[54:55]
    v_pk_mul_f32 v[98:99], v[98:99], s[54:55]
    s_nop 1
    v_cvt_pk_bf16_f32 v96, v96, v104
    v_cvt_pk_bf16_f32 v97, v97, v105
    v_cvt_pk_bf16_f32 v98, v98, v106
    v_cvt_pk_bf16_f32 v99, v99, v107
    v_mov_b32_dpp v80, v96 row_ror:8 row_mask:0xf bank_mask:0xc
    v_mov_b32_dpp v81, v97 row_ror:8 row_mask:0xf bank_mask:0xc
    v_mov_b32_dpp v82, v98 row_ror:8 row_mask:0xf bank_mask:0xc
    v_mov_b32_dpp v83, v99 row_ror:8 row_mask:0xf bank_mask:0xc
    v_mov_b32_dpp v88, v96 row_ror:8 row_mask:0xf bank_mask:0x3
    v_mov_b32_dpp v89, v97 row_ror:8 row_mask:0xf bank_mask:0x3
    v_mov_b32_dpp v90, v98 row_ror:8 row_mask:0xf bank_mask:0x3
    v_mov_b32_dpp v91, v99 row_ror:8 row_mask:0xf bank_mask:0x3
    s_setprio 1
    buffer_store_dwordx4 v[80:83], v8, s[40:43], s60 offen offset:0 sc1
    s_setprio 0
    s_setprio 1
    buffer_store_dwordx4 v[88:91], v15, s[40:43], s60 offen offset:0 sc1
    s_setprio 0
    v_pk_mul_f32 v[100:101], v[100:101], s[54:55]
    v_pk_mul_f32 v[102:103], v[102:103], s[54:55]
    v_cvt_pk_bf16_f32 v100, v100, v108
    v_cvt_pk_bf16_f32 v101, v101, v109
    v_cvt_pk_bf16_f32 v102, v102, v110
    v_cvt_pk_bf16_f32 v103, v103, v111
    v_mov_b32_dpp v84, v100 row_ror:8 row_mask:0xf bank_mask:0xc
    v_mov_b32_dpp v85, v101 row_ror:8 row_mask:0xf bank_mask:0xc
    v_mov_b32_dpp v86, v102 row_ror:8 row_mask:0xf bank_mask:0xc
    v_mov_b32_dpp v87, v103 row_ror:8 row_mask:0xf bank_mask:0xc
    v_mov_b32_dpp v92, v100 row_ror:8 row_mask:0xf bank_mask:0x3
    v_mov_b32_dpp v93, v101 row_ror:8 row_mask:0xf bank_mask:0x3
    v_mov_b32_dpp v94, v102 row_ror:8 row_mask:0xf bank_mask:0x3
    v_mov_b32_dpp v95, v103 row_ror:8 row_mask:0xf bank_mask:0x3
    s_setprio 1
    buffer_store_dwordx4 v[84:87], v8, s[40:43], s60 offen offset:2048 sc1
    s_setprio 0
    s_setprio 1
    buffer_store_dwordx4 v[92:95], v15, s[40:43], s60 offen offset:2048 sc1
    s_setprio 0
kf_xs:
    ds_read_b32 v4, v3 offset:1576
    s_waitcnt lgkmcnt(0)
    v_readfirstlane_b32 s53, v4
    s_cmp_ge_u32 s53, 8
    s_cbranch_scc1 kf_xs_ok
    s_sleep 1
    s_branch kf_xs
kf_xs_ok:
    s_mov_b64 exec, s[68:69]
    ds_write_b128 v9, v[16:19] offset:51200
    ds_write_b128 v10, v[20:23] offset:51200
    s_mov_b64 exec, s[70:71]
    ds_write_b128 v9, v[32:35] offset:53248
    ds_write_b128 v10, v[36:39] offset:53248
    s_mov_b64 exec, -1
    s_cmp_lg_u32 s3, 6
    s_cbranch_scc1 kf_g1
    s_cmp_lg_u32 s29, 127
    s_cbranch_scc1 kf_g1
    v_mov_b32 v4, 0x7f7f
    v_lshlrev_b32 v6, 2, v1
    s_add_u32 s31, s30, 3211264
    s_bfm_b64 exec, 32, 0
    buffer_store_dword v4, v6, s[32:35], s31 offen sc1
    s_mov_b64 exec, -1
kf_g1:
    s_lshl_b32 s52, s29, 7
    s_lshl_b32 s53, s28, 14
    s_add_u32 s52, s52, s53
    s_add_u32 s52, s52, 17797120
    s_waitcnt vmcnt(0)
    s_mov_b64 exec, 1
    ds_add_rtn_u32 v4, v3, v14 offset:1564
    s_waitcnt lgkmcnt(0)
    v_readfirstlane_b32 s53, v4
    s_cmp_lg_u32 s53, 6
    s_cbranch_scc1 kf_g2
kf_zg:
    ds_read_b32 v4, v3 offset:1548
    s_waitcnt lgkmcnt(0)
    v_readfirstlane_b32 s53, v4
    s_cmp_ge_u32 s53, 1
    s_cbranch_scc1 kf_zg_ok
    s_sleep 1
    s_branch kf_zg
kf_zg_ok:
    buffer_store_dword v14, off, s[32:35], s52 sc1
kf_g2:
    s_mov_b64 exec, -1
    s_lshl_b32 s31, s3, 13
    s_add_u32 s31, s31, 21504
    v_lshl_add_u32 v6, v1, 4, s31
    v_mov_b32 v48, 0
    v_mov_b32 v49, 0
    v_mov_b32 v50, 0
    v_mov_b32 v51, 0
kf_gz:
    ds_read_b32 v4, v3 offset:1580
    s_waitcnt lgkmcnt(0)
    v_readfirstlane_b32 s53, v4
    s_cmp_ge_u32 s53, 7
    s_cbranch_scc1 kf_gz_ok
    s_sleep 1
    s_branch kf_gz
kf_gz_ok:
    ds_write_b128 v6, v[48:51] offset:0
    ds_write_b128 v6, v[48:51] offset:1024
    ds_write_b128 v6, v[48:51] offset:2048
    ds_write_b128 v6, v[48:51] offset:3072
    ds_write_b128 v6, v[48:51] offset:4096
    ds_write_b128 v6, v[48:51] offset:5120
    ds_write_b128 v6, v[48:51] offset:6144
    ds_write_b128 v6, v[48:51] offset:7168
    s_mov_b64 exec, 1
    ds_add_u32 v3, v14 offset:1584
    s_mov_b64 exec, -1
    s_cmp_ge_u32 s3, 4
    s_cbranch_scc1 kf_tp2
kf_zt:
    ds_read_b32 v4, v3 offset:1548
    s_waitcnt lgkmcnt(0)
    v_readfirstlane_b32 s53, v4
    s_cmp_ge_u32 s53, 1
    s_cbranch_scc1 kf_zt_ok
    s_sleep 1
    s_branch kf_zt
kf_zt_ok:
    s_and_b32 s62, s29, 31
    s_lshl_b32 s63, s3, 5
    s_add_u32 s62, s62, s63
    s_cmp_eq_u32 s62, -1
    s_cbranch_scc1 kf_tp2
    s_lshl_b32 s52, s62, 7
    s_lshl_b32 s53, s28, 14
    s_add_u32 s52, s52, s53
    s_add_u32 s52, s52, 17797120
    s_mov_b32 s80, 32768
    v_lshlrev_b32 v30, 7, v1
    s_mul_i32 s62, s62, 25088
    s_add_u32 s62, s62, s30
kf_tp:
    buffer_load_dword v31, off, s[32:35], s52 sc1
    s_waitcnt vmcnt(0)
    v_readfirstlane_b32 s53, v31
    s_cmp_lg_u32 s53, 0
    s_cbranch_scc1 kf_tp1
    s_sub_u32 s80, s80, 1
    s_cbranch_scc1 kf_tp2
    s_sleep 8
    s_branch kf_tp
kf_tp1:
kf_tpw:
    ds_read_b32 v4, v3 offset:1572
    s_waitcnt lgkmcnt(0)
    v_readfirstlane_b32 s53, v4
    s_cmp_ge_u32 s53, 8
    s_cbranch_scc1 kf_tpw_ok
    s_sleep 2
    s_branch kf_tpw
kf_tpw_ok:
    s_bfm_b64 exec, 49, 0
    buffer_load_dword v96, v30, s[32:35], s62 offen sc1
    s_add_u32 s62, s62, 6272
    buffer_load_dword v96, v30, s[32:35], s62 offen sc1
    s_add_u32 s62, s62, 6272
    s_mov_b64 exec, -1
kf_tp2:
kf_gp:
    ds_read_b32 v4, v3 offset:1560
    s_waitcnt lgkmcnt(0)
    v_readfirstlane_b32 s53, v4
    s_cmp_ge_u32 s53, 1
    s_cbranch_scc1 kf_gp_ok
    s_sleep 2
    s_branch kf_gp
kf_gp_ok:
    s_mov_b32 s91, s53
    s_lshl_b32 s95, s3, 4
    v_mov_b32 v14, s95
    v_lshlrev_b32 v15, 4, v1
    ds_read_b128 v[124:127], v14 offset:3712
    ds_read_b128 v[4:7], v15 offset:4096
    ds_read_b128 v[104:107], v15 offset:5120
    v_and_b32 v14, 15, v1
    v_lshrrev_b32 v15, 4, v1
    v_lshlrev_b32 v15, 2, v15
    v_sub_u32 v14, v14, v15
    v_mov_b32 v15, 0x3f80
    v_cmp_eq_u32 vcc, 0, v14
    s_nop 1
    v_cndmask_b32 v8, 0, v15, vcc
    v_cmp_eq_u32 vcc, 1, v14
    s_nop 1
    v_cndmask_b32 v9, 0, v15, vcc
    v_cmp_eq_u32 vcc, 2, v14
    s_nop 1
    v_cndmask_b32 v10, 0, v15, vcc
    v_cmp_eq_u32 vcc, 3, v14
    s_nop 1
    v_cndmask_b32 v11, 0, v15, vcc
    s_add_u32 s36, s26, s30
    s_addc_u32 s37, s27, 0
    s_and_b32 s37, s37, 0xffff
    s_or_b32 s37, s37, 8388608
    s_mov_b32 s38, 50192
    s_mov_b32 s39, 0x00020000
    s_mul_i32 s31, s29, 50176
    s_add_u32 s46, s31, 50176
    s_min_u32 s46, s46, 6400000
    s_mov_b32 s44, s22
    s_and_b32 s45, s23, 0xffff
    s_mov_b32 s47, 0x00020000
    s_add_u32 s31, s31, s94
    v_lshrrev_b32 v14, 3, v1
    v_lshlrev_b32 v15, 2, v14
    s_waitcnt lgkmcnt(2)
    v_bfe_u32 v112, v124, 24, 5
    v_lshl_add_u32 v112, v112, 5, v15
    ds_read_b32 v112, v112 offset:1600
    v_bfe_u32 v113, v125, 24, 5
    v_lshl_add_u32 v113, v113, 5, v15
    ds_read_b32 v113, v113 offset:1600
    v_bfe_u32 v114, v126, 24, 5
    v_lshl_add_u32 v114, v114, 5, v15
    ds_read_b32 v114, v114 offset:1600
    v_bfe_u32 v115, v127, 24, 5
    v_lshl_add_u32 v115, v115, 5, v15
    ds_read_b32 v115, v115 offset:1600
    v_readfirstlane_b32 s87, v124
    v_readfirstlane_b32 s88, v125
    v_readfirstlane_b32 s89, v126
    v_readfirstlane_b32 s90, v127
    s_and_b32 s86, s87, 0xfff
    s_lshl_b32 s95, s86, 4
    s_add_u32 s95, s95, 7168
    v_lshl_add_u32 v12, v14, 1, s95
    s_lshl_b32 s95, s86, 6
    s_add_u32 s95, s95, 21504
    v_and_b32 v13, 12, v1
    v_lshl_add_u32 v13, v13, 2, s95
    s_lshr_b32 s72, s87, 29
    s_bfe_u32 s87, s87, 0xc000c
    s_lshr_b32 s73, s88, 29
    s_bfe_u32 s88, s88, 0xc000c
    s_lshr_b32 s74, s89, 29
    s_bfe_u32 s89, s89, 0xc000c
    s_lshr_b32 s75, s90, 29
    s_bfe_u32 s90, s90, 0xc000c
    v_and_b32 v14, 7, v1
    v_lshlrev_b32 v15, 3, v14
    s_mov_b32 s76, 0x22221111
    s_mov_b32 s77, 0x88884444
    s_mov_b32 s78, 1.0
    s_mov_b32 s79, 1.0
    s_sub_u32 s86, s87, 2
    s_mul_i32 s95, s72, 25600
    s_add_u32 s95, s95, 87040
    s_lshl_b32 s93, s72, 6
    s_waitcnt lgkmcnt(3)
    v_xor_b32 v124, v112, v14
    v_and_b32 v124, 7, v124
    v_lshl_add_u32 v124, v124, 4, s95
    v_lshl_add_u32 v124, v112, 7, v124
    v_and_b32 v108, 7, v112
    v_lshlrev_b32 v108, 4, v108
    v_lshl_add_u32 v108, v112, 7, v108
    v_lshl_add_u32 v112, v112, 8, v15
    v_xor_b32 v108, v108, v15
    v_or_b32 v112, s93, v112
    v_xor_b32 v108, s93, v108
    v_add_u32 v108, 138240, v108
    s_mul_i32 s95, s73, 25600
    s_add_u32 s95, s95, 87040
    s_lshl_b32 s93, s73, 6
    s_waitcnt lgkmcnt(2)
    v_xor_b32 v125, v113, v14
    v_and_b32 v125, 7, v125
    v_lshl_add_u32 v125, v125, 4, s95
    v_lshl_add_u32 v125, v113, 7, v125
    v_and_b32 v109, 7, v113
    v_lshlrev_b32 v109, 4, v109
    v_lshl_add_u32 v109, v113, 7, v109
    v_lshl_add_u32 v113, v113, 8, v15
    v_xor_b32 v109, v109, v15
    v_or_b32 v113, s93, v113
    v_xor_b32 v109, s93, v109
    v_add_u32 v109, 138240, v109
    s_mul_i32 s95, s74, 25600
    s_add_u32 s95, s95, 87040
    s_lshl_b32 s93, s74, 6
    s_waitcnt lgkmcnt(1)
    v_xor_b32 v126, v114, v14
    v_and_b32 v126, 7, v126
    v_lshl_add_u32 v126, v126, 4, s95
    v_lshl_add_u32 v126, v114, 7, v126
    v_and_b32 v110, 7, v114
    v_lshlrev_b32 v110, 4, v110
    v_lshl_add_u32 v110, v114, 7, v110
    v_lshl_add_u32 v114, v114, 8, v15
    v_xor_b32 v110, v110, v15
    v_or_b32 v114, s93, v114
    v_xor_b32 v110, s93, v110
    v_add_u32 v110, 138240, v110
    s_mul_i32 s95, s75, 25600
    s_add_u32 s95, s95, 87040
    s_lshl_b32 s93, s75, 6
    s_waitcnt lgkmcnt(0)
    v_xor_b32 v127, v115, v14
    v_and_b32 v127, 7, v127
    v_lshl_add_u32 v127, v127, 4, s95
    v_lshl_add_u32 v127, v115, 7, v127
    v_and_b32 v111, 7, v115
    v_lshlrev_b32 v111, 4, v111
    v_lshl_add_u32 v111, v115, 7, v111
    v_lshl_add_u32 v115, v115, 8, v15
    v_xor_b32 v111, v111, v15
    v_or_b32 v115, s93, v115
    v_xor_b32 v111, s93, v111
    v_add_u32 v111, 138240, v111
    s_branch kf_join
kf_plan:
    s_mov_b32 s48, s16
    s_and_b32 s49, s17, 0xffff
    s_mov_b32 s50, 1024
    s_mov_b32 s51, 0x00020000
    s_mov_b32 s72, s24
    s_and_b32 s73, s25, 0xffff
    s_mov_b32 s74, 256
    s_mov_b32 s75, 0x00020000
    v_min_u32 v13, 31, v1
    v_lshlrev_b32 v13, 2, v13
    v_lshlrev_b32 v2, 2, v1
    s_lshl_b32 s52, s91, 2
    s_cmp_lt_u32 s91, 32
    s_cselect_b32 s54, 1, 0
    s_mov_b32 s55, 0
    s_mov_b64 exec, s[54:55]
    s_waitcnt vmcnt(0)
    buffer_store_dword v14, off, s[72:75], s52 offset:128 sc1
    s_mov_b64 exec, -1
    v_and_b32 v4, 7, v1
    v_lshl_add_u32 v6, v4, 2, v7
    v_lshlrev_b32 v6, 1, v6
    s_mov_b32 s56, 0x19342a02
    v_writelane_b32 v24, s56, 0
    s_mov_b32 s56, 0x19221608
    v_writelane_b32 v24, s56, 1
    s_mov_b32 s56, 0x192d2c06
    v_writelane_b32 v24, s56, 2
    s_mov_b32 s56, 0x1921140f
    v_writelane_b32 v24, s56, 3
    s_mov_b32 s56, 0x19371300
    v_writelane_b32 v24, s56, 4
    s_mov_b32 s56, 0x192e2b04
    v_writelane_b32 v24, s56, 5
    s_mov_b32 s56, 0x19201712
    v_writelane_b32 v24, s56, 6
    s_mov_b32 s56, 0x3532180b
    v_writelane_b32 v24, s56, 7
    s_mov_b32 s56, 0x1928270e
    v_writelane_b32 v24, s56, 8
    s_mov_b32 s56, 0x19290d05
    v_writelane_b32 v24, s56, 9
    s_mov_b32 s56, 0x19362603
    v_writelane_b32 v24, s56, 10
    s_mov_b32 s56, 0x192f2507
    v_writelane_b32 v24, s56, 11
    s_mov_b32 s56, 0x1923110c
    v_writelane_b32 v24, s56, 12
    s_mov_b32 s56, 0x19313001
    v_writelane_b32 v24, s56, 13
    s_mov_b32 s56, 0x3833150a
    v_writelane_b32 v24, s56, 14
    s_mov_b32 s56, 0x19241009
    v_writelane_b32 v24, s56, 15
    s_mov_b64 exec, 0xffff
    ds_write_b32 v2, v24 offset:3712
    s_mov_b64 exec, -1
    ds_read_u8 v25, v1 offset:3712
kf_zd:
    ds_read_b32 v4, v3 offset:1540
    s_waitcnt lgkmcnt(0)
    v_readfirstlane_b32 s53, v4
    s_cmp_ge_u32 s53, 8
    s_cbranch_scc1 kf_zd_ok
    s_sleep 1
    s_branch kf_zd
kf_zd_ok:
    buffer_load_dword v15, v13, s[72:75], 0 offen offset:128 sc1
    s_mov_b32 s80, 32768
kf_za:
    s_waitcnt vmcnt(0)
    v_cmp_ne_u32 vcc, 0, v15
    s_cmp_eq_u64 vcc, -1
    s_cbranch_scc1 kf_za_ok
    s_sleep 6
    s_not_b64 exec, vcc
    buffer_load_dword v15, v13, s[72:75], 0 offen offset:128 sc1
    s_mov_b64 exec, -1
    s_sub_u32 s80, s80, 1
    s_cbranch_scc0 kf_za
    s_waitcnt vmcnt(0)
kf_za_ok:
    ds_write_b32 v3, v14 offset:1548
    buffer_load_ushort v32, v6, s[48:51], s94 offen offset:0
    buffer_load_ushort v33, v6, s[48:51], s94 offen offset:256
    buffer_load_ushort v34, v6, s[48:51], s94 offen offset:512
    buffer_load_ushort v35, v6, s[48:51], s94 offen offset:768
    buffer_load_ushort v36, v6, s[48:51], s94 offen offset:64
    buffer_load_ushort v37, v6, s[48:51], s94 offen offset:320
    buffer_load_ushort v38, v6, s[48:51], s94 offen offset:576
    buffer_load_ushort v39, v6, s[48:51], s94 offen offset:832
    s_mov_b32 s95, 0xbfb8aa3b
    v_and_b32 v18, 8, v1
    v_cmp_eq_u32 vcc, 0, v18
    v_lshlrev_b32 v18, 4, v1
    s_waitcnt vmcnt(0)
    v_lshlrev_b32 v32, 16, v32
    v_mul_f32 v32, s95, v32
    v_lshlrev_b32 v33, 16, v33
    v_mul_f32 v33, s95, v33
    v_lshlrev_b32 v34, 16, v34
    v_mul_f32 v34, s95, v34
    v_lshlrev_b32 v35, 16, v35
    v_mul_f32 v35, s95, v35
    v_lshlrev_b32 v36, 16, v36
    v_mul_f32 v36, s95, v36
    v_lshlrev_b32 v37, 16, v37
    v_mul_f32 v37, s95, v37
    v_lshlrev_b32 v38, 16, v38
    v_mul_f32 v38, s95, v38
    v_lshlrev_b32 v39, 16, v39
    v_mul_f32 v39, s95, v39
    v_cvt_pk_bf16_f32 v16, v32, v33
    v_cvt_pk_bf16_f32 v17, v34, v35
    v_cndmask_b32 v32, 0, v16, vcc
    v_cndmask_b32 v33, 0, v17, vcc
    v_cndmask_b32 v34, v16, 0, vcc
    v_cndmask_b32 v35, v17, 0, vcc
    ds_write_b128 v18, v[32:35] offset:4096
    v_cvt_pk_bf16_f32 v16, v36, v37
    v_cvt_pk_bf16_f32 v17, v38, v39
    v_cndmask_b32 v36, 0, v16, vcc
    v_cndmask_b32 v37, 0, v17, vcc
    v_cndmask_b32 v38, v16, 0, vcc
    v_cndmask_b32 v39, v17, 0, vcc
    ds_write_b128 v18, v[36:39] offset:5120
    s_waitcnt lgkmcnt(0)
    v_and_b32 v26, 31, v25
    v_cmp_gt_u32 vcc, 25, v26
    s_nop 1
    v_cndmask_b32 v27, 0, 3, vcc
    v_lshlrev_b32 v26, 2, v26
    v_lshrrev_b32 v29, 5, v25
    v_lshl_or_b32 v29, v29, 1, v26
    v_lshlrev_b32 v25, 24, v25
    s_mov_b32 s56, 0x80008
    v_add_u32 v56, 0, v1
    v_add_u32 v57, 64, v1
    v_add_u32 v58, 128, v1
    v_add_u32 v59, 192, v1
kf_pp:
    ds_read_b32 v4, v3 offset:1556
    s_waitcnt lgkmcnt(0)
    v_readfirstlane_b32 s53, v4
    s_cmp_ge_u32 s53, 8
    s_cbranch_scc1 kf_pp_ok
    s_sleep 1
    s_branch kf_pp
kf_pp_ok:
    ds_read_b32 v32, v2 offset:0
    ds_read_b32 v33, v2 offset:256
    ds_read_b32 v34, v2 offset:512
    s_mov_b64 exec, 0xff
    ds_read_b32 v35, v2 offset:768
    s_mov_b64 exec, -1
    ds_read_b32 v28, v3 offset:1568
    s_waitcnt lgkmcnt(4)
    v_min_u32 v40, 63, v32
    v_sub_u32 v40, 63, v40
    v_lshlrev_b32 v40, 2, v40
    ds_add_rtn_u32 v48, v40, v14 offset:1024
    s_waitcnt lgkmcnt(4)
    v_min_u32 v41, 63, v33
    v_sub_u32 v41, 63, v41
    v_lshlrev_b32 v41, 2, v41
    ds_add_rtn_u32 v49, v41, v14 offset:1024
    s_waitcnt lgkmcnt(4)
    v_min_u32 v42, 63, v34
    v_sub_u32 v42, 63, v42
    v_lshlrev_b32 v42, 2, v42
    ds_add_rtn_u32 v50, v42, v14 offset:1024
    s_mov_b64 exec, 0xff
    s_waitcnt lgkmcnt(4)
    v_min_u32 v43, 63, v35
    v_sub_u32 v43, 63, v43
    v_lshlrev_b32 v43, 2, v43
    ds_add_rtn_u32 v51, v43, v14 offset:1024
    s_mov_b64 exec, -1
    ds_read_b32 v16, v2 offset:1024
    s_waitcnt lgkmcnt(0)
    v_mov_b32 v17, v16
    s_nop 1
    v_add_u32_dpp v17, v17, v17 row_shr:1 row_mask:0xf bank_mask:0xf bound_ctrl:1
    s_nop 1
    v_add_u32_dpp v17, v17, v17 row_shr:2 row_mask:0xf bank_mask:0xf bound_ctrl:1
    s_nop 1
    v_add_u32_dpp v17, v17, v17 row_shr:4 row_mask:0xf bank_mask:0xf bound_ctrl:1
    s_nop 1
    v_add_u32_dpp v17, v17, v17 row_shr:8 row_mask:0xf bank_mask:0xf bound_ctrl:1
    s_nop 1
    v_add_u32_dpp v17, v17, v17 row_bcast:15 row_mask:0xa bank_mask:0xf
    s_nop 1
    v_add_u32_dpp v17, v17, v17 row_bcast:31 row_mask:0xc bank_mask:0xf
    v_sub_u32 v17, v17, v16
    ds_bpermute_b32 v40, v40, v17
    ds_bpermute_b32 v41, v41, v17
    ds_bpermute_b32 v42, v42, v17
    ds_bpermute_b32 v43, v43, v17
    s_waitcnt lgkmcnt(3)
    v_add_u32 v48, v48, v40
    v_lshrrev_b32 v40, 3, v48
    v_lshlrev_b32 v40, 2, v40
    ds_max_u32 v40, v32 offset:1280
    v_lshlrev_b32 v18, 2, v48
    ds_write_b32 v18, v56 offset:1600
    s_waitcnt lgkmcnt(4)
    v_add_u32 v49, v49, v41
    v_lshrrev_b32 v41, 3, v49
    v_lshlrev_b32 v41, 2, v41
    ds_max_u32 v41, v33 offset:1280
    v_lshlrev_b32 v18, 2, v49
    ds_write_b32 v18, v57 offset:1600
    s_waitcnt lgkmcnt(5)
    v_add_u32 v50, v50, v42
    v_lshrrev_b32 v42, 3, v50
    v_lshlrev_b32 v42, 2, v42
    ds_max_u32 v42, v34 offset:1280
    v_lshlrev_b32 v18, 2, v50
    ds_write_b32 v18, v58 offset:1600
    s_mov_b64 exec, 0xff
    s_waitcnt lgkmcnt(6)
    v_add_u32 v51, v51, v43
    v_lshrrev_b32 v43, 3, v51
    v_lshlrev_b32 v43, 2, v43
    ds_max_u32 v43, v35 offset:1280
    v_lshlrev_b32 v18, 2, v51
    ds_write_b32 v18, v59 offset:1600
    s_mov_b64 exec, -1
    ds_read_b32 v16, v26 offset:1280
    v_and_b32 v48, 7, v48
    v_mul_u32_u24 v48, s56, v48
    v_and_b32 v49, 7, v49
    v_mul_u32_u24 v49, s56, v49
    v_and_b32 v50, 7, v50
    v_mul_u32_u24 v50, s56, v50
    v_and_b32 v51, 7, v51
    v_mul_u32_u24 v51, s56, v51
    v_readfirstlane_b32 s54, v28
    s_waitcnt lgkmcnt(0)
    v_max_u32 v16, v16, v27
    v_mov_b32 v17, v16
    s_nop 1
    v_add_u32_dpp v17, v17, v17 row_shr:1 row_mask:0xf bank_mask:0xf bound_ctrl:1
    s_nop 1
    v_add_u32_dpp v17, v17, v17 row_shr:2 row_mask:0xf bank_mask:0xf bound_ctrl:1
    s_nop 1
    v_add_u32_dpp v17, v17, v17 row_shr:4 row_mask:0xf bank_mask:0xf bound_ctrl:1
    s_nop 1
    v_add_u32_dpp v17, v17, v17 row_shr:8 row_mask:0xf bank_mask:0xf bound_ctrl:1
    s_nop 1
    v_add_u32_dpp v17, v17, v17 row_bcast:15 row_mask:0xa bank_mask:0xf
    s_nop 1
    v_add_u32_dpp v17, v17, v17 row_bcast:31 row_mask:0xc bank_mask:0xf
    s_nop 0
    v_readlane_b32 s55, v17, 63
    v_sub_u32 v17, v17, v16
    v_lshlrev_b32 v18, 6, v17
    ds_write_b16 v29, v18 offset:3584
    ds_read_b32 v40, v40 offset:3584
    ds_read_b32 v41, v41 offset:3584
    ds_read_b32 v42, v42 offset:3584
    s_mov_b64 exec, 0xff
    ds_read_b32 v43, v43 offset:3584
    s_mov_b64 exec, -1
    v_and_b32 v16, 0xfff, v16
    v_and_b32 v17, 0xfff, v17
    v_lshl_or_b32 v17, v16, 12, v17
    v_or_b32 v17, v17, v25
    ds_write_b32 v2, v17 offset:3712
    s_or_b32 s55, s55, s54
    s_cmp_gt_u32 s55, 896
    s_cselect_b32 s53, 2, 1
    v_mov_b32 v19, s53
    s_waitcnt lgkmcnt(4)
    v_add_u32 v40, v48, v40
    ds_write_b32 v2, v40 offset:0
    s_waitcnt lgkmcnt(4)
    v_add_u32 v41, v49, v41
    ds_write_b32 v2, v41 offset:256
    s_waitcnt lgkmcnt(4)
    v_add_u32 v42, v50, v42
    ds_write_b32 v2, v42 offset:512
    s_mov_b64 exec, 0xff
    s_waitcnt lgkmcnt(4)
    v_add_u32 v43, v51, v43
    ds_write_b32 v2, v43 offset:768
    s_mov_b64 exec, -1
    ds_write_b32 v3, v19 offset:1560
    s_lshl_b32 s81, s28, 14
    s_add_u32 s81, s81, 17797120
    s_add_u32 s82, s81, 8192
    v_lshlrev_b32 v2, 7, v1
    s_mov_b32 s91, s53
    s_lshl_b32 s95, s3, 4
    v_mov_b32 v14, s95
    v_lshlrev_b32 v15, 4, v1
    ds_read_b128 v[124:127], v14 offset:3712
    ds_read_b128 v[4:7], v15 offset:4096
    ds_read_b128 v[104:107], v15 offset:5120
    v_and_b32 v14, 15, v1
    v_lshrrev_b32 v15, 4, v1
    v_lshlrev_b32 v15, 2, v15
    v_sub_u32 v14, v14, v15
    v_mov_b32 v15, 0x3f80
    v_cmp_eq_u32 vcc, 0, v14
    s_nop 1
    v_cndmask_b32 v8, 0, v15, vcc
    v_cmp_eq_u32 vcc, 1, v14
    s_nop 1
    v_cndmask_b32 v9, 0, v15, vcc
    v_cmp_eq_u32 vcc, 2, v14
    s_nop 1
    v_cndmask_b32 v10, 0, v15, vcc
    v_cmp_eq_u32 vcc, 3, v14
    s_nop 1
    v_cndmask_b32 v11, 0, v15, vcc
    s_add_u32 s36, s26, s30
    s_addc_u32 s37, s27, 0
    s_and_b32 s37, s37, 0xffff
    s_or_b32 s37, s37, 8388608
    s_mov_b32 s38, 50192
    s_mov_b32 s39, 0x00020000
    s_mul_i32 s31, s29, 50176
    s_add_u32 s46, s31, 50176
    s_min_u32 s46, s46, 6400000
    s_mov_b32 s44, s22
    s_and_b32 s45, s23, 0xffff
    s_mov_b32 s47, 0x00020000
    s_add_u32 s31, s31, s94
    v_lshrrev_b32 v14, 3, v1
    v_lshlrev_b32 v15, 2, v14
    s_waitcnt lgkmcnt(2)
    v_bfe_u32 v112, v124, 24, 5
    v_lshl_add_u32 v112, v112, 5, v15
    ds_read_b32 v112, v112 offset:1600
    v_bfe_u32 v113, v125, 24, 5
    v_lshl_add_u32 v113, v113, 5, v15
    ds_read_b32 v113, v113 offset:1600
    v_bfe_u32 v114, v126, 24, 5
    v_lshl_add_u32 v114, v114, 5, v15
    ds_read_b32 v114, v114 offset:1600
    v_bfe_u32 v115, v127, 24, 5
    v_lshl_add_u32 v115, v115, 5, v15
    ds_read_b32 v115, v115 offset:1600
    v_readfirstlane_b32 s87, v124
    v_readfirstlane_b32 s88, v125
    v_readfirstlane_b32 s89, v126
    v_readfirstlane_b32 s90, v127
    s_and_b32 s86, s87, 0xfff
    s_lshl_b32 s95, s86, 4
    s_add_u32 s95, s95, 7168
    v_lshl_add_u32 v12, v14, 1, s95
    s_lshl_b32 s95, s86, 6
    s_add_u32 s95, s95, 21504
    v_and_b32 v13, 12, v1
    v_lshl_add_u32 v13, v13, 2, s95
    s_lshr_b32 s72, s87, 29
    s_bfe_u32 s87, s87, 0xc000c
    s_lshr_b32 s73, s88, 29
    s_bfe_u32 s88, s88, 0xc000c
    s_lshr_b32 s74, s89, 29
    s_bfe_u32 s89, s89, 0xc000c
    s_lshr_b32 s75, s90, 29
    s_bfe_u32 s90, s90, 0xc000c
    v_and_b32 v14, 7, v1
    v_lshlrev_b32 v15, 3, v14
    s_mov_b32 s76, 0x22221111
    s_mov_b32 s77, 0x88884444
    s_mov_b32 s78, 1.0
    s_mov_b32 s79, 1.0
    s_sub_u32 s86, s87, 2
    s_mul_i32 s95, s72, 25600
    s_add_u32 s95, s95, 87040
    s_lshl_b32 s93, s72, 6
    s_waitcnt lgkmcnt(3)
    v_xor_b32 v124, v112, v14
    v_and_b32 v124, 7, v124
    v_lshl_add_u32 v124, v124, 4, s95
    v_lshl_add_u32 v124, v112, 7, v124
    v_and_b32 v108, 7, v112
    v_lshlrev_b32 v108, 4, v108
    v_lshl_add_u32 v108, v112, 7, v108
    v_lshl_add_u32 v112, v112, 8, v15
    v_xor_b32 v108, v108, v15
    v_or_b32 v112, s93, v112
    v_xor_b32 v108, s93, v108
    v_add_u32 v108, 138240, v108
    s_mul_i32 s95, s73, 25600
    s_add_u32 s95, s95, 87040
    s_lshl_b32 s93, s73, 6
    s_waitcnt lgkmcnt(2)
    v_xor_b32 v125, v113, v14
    v_and_b32 v125, 7, v125
    v_lshl_add_u32 v125, v125, 4, s95
    v_lshl_add_u32 v125, v113, 7, v125
    v_and_b32 v109, 7, v113
    v_lshlrev_b32 v109, 4, v109
    v_lshl_add_u32 v109, v113, 7, v109
    v_lshl_add_u32 v113, v113, 8, v15
    v_xor_b32 v109, v109, v15
    v_or_b32 v113, s93, v113
    v_xor_b32 v109, s93, v109
    v_add_u32 v109, 138240, v109
    s_mul_i32 s95, s74, 25600
    s_add_u32 s95, s95, 87040
    s_lshl_b32 s93, s74, 6
    s_waitcnt lgkmcnt(1)
    v_xor_b32 v126, v114, v14
    v_and_b32 v126, 7, v126
    v_lshl_add_u32 v126, v126, 4, s95
    v_lshl_add_u32 v126, v114, 7, v126
    v_and_b32 v110, 7, v114
    v_lshlrev_b32 v110, 4, v110
    v_lshl_add_u32 v110, v114, 7, v110
    v_lshl_add_u32 v114, v114, 8, v15
    v_xor_b32 v110, v110, v15
    v_or_b32 v114, s93, v114
    v_xor_b32 v110, s93, v110
    v_add_u32 v110, 138240, v110
    s_mul_i32 s95, s75, 25600
    s_add_u32 s95, s95, 87040
    s_lshl_b32 s93, s75, 6
    s_waitcnt lgkmcnt(0)
    v_xor_b32 v127, v115, v14
    v_and_b32 v127, 7, v127
    v_lshl_add_u32 v127, v127, 4, s95
    v_lshl_add_u32 v127, v115, 7, v127
    v_and_b32 v111, 7, v115
    v_lshlrev_b32 v111, 4, v111
    v_lshl_add_u32 v111, v115, 7, v111
    v_lshl_add_u32 v115, v115, 8, v15
    v_xor_b32 v111, v111, v15
    v_or_b32 v115, s93, v115
    v_xor_b32 v111, s93, v111
    v_add_u32 v111, 138240, v111
kf_tw:
    ds_read_b32 v14, v3 offset:1564
    s_waitcnt lgkmcnt(0)
    v_readfirstlane_b32 s53, v14
    s_cmp_ge_u32 s53, 7
    s_cbranch_scc1 kf_tw_ok
    s_sleep 2
    s_branch kf_tw
kf_tw_ok:
    buffer_load_dword v16, v2, s[32:35], s81 offen sc1
    buffer_load_dword v17, v2, s[32:35], s82 offen sc1
    s_mov_b32 s80, 32768
kf_pt:
    s_waitcnt vmcnt(0)
    v_and_b32 v18, v16, v17
    v_cmp_ne_u32 vcc, 0, v18
    s_cmp_eq_u64 vcc, -1
    s_cbranch_scc1 kf_pt_ok
    s_sleep 6
    s_not_b64 exec, vcc
    buffer_load_dword v16, v2, s[32:35], s81 offen sc1
    buffer_load_dword v17, v2, s[32:35], s82 offen sc1
    s_mov_b64 exec, -1
    s_sub_u32 s80, s80, 1
    s_cbranch_scc0 kf_pt
    s_waitcnt vmcnt(0)
kf_pt_ok:
    s_branch kf_join
kf_rec:
    s_setprio 3
    v_lshlrev_b32 v4, 3, v0
    v_add_u32 v4, -4096, v4
    v_lshlrev_b32 v8, 1, v4
    s_mul_i32 s76, s2, 6256
    s_mul_i32 s82, s2, 12512
    s_movk_i32 s31, 782
    s_cmp_eq_u32 s2, 255
    s_cselect_b32 s31, 590, s31
    v_cmp_gt_u32 s[88:89], s31, v0
    s_add_u32 s77, s76, 4096
    s_add_u32 s83, s82, 8192
    s_waitcnt lgkmcnt(0)
    s_mov_b32 s56, s10
    s_and_b32 s57, s11, 0xffff
    s_mov_b32 s58, 1600000
    s_mov_b32 s59, 0x00020000
    s_mov_b32 s64, s8
    s_and_b32 s65, s9, 0xffff
    s_mov_b32 s66, 1600000
    s_mov_b32 s67, 0x00020000
    s_mov_b32 s68, s6
    s_and_b32 s69, s7, 0xffff
    s_mov_b32 s70, 3200000
    s_mov_b32 s71, 0x00020000
    buffer_load_dwordx2 v[32:33], v4, s[56:59], s76 offen nt
    s_mov_b64 exec, s[88:89]
    buffer_load_dwordx2 v[34:35], v4, s[56:59], s77 offen nt
    s_mov_b64 exec, -1
    buffer_load_dwordx2 v[36:37], v4, s[64:67], s76 offen nt
    s_mov_b64 exec, s[88:89]
    buffer_load_dwordx2 v[38:39], v4, s[64:67], s77 offen nt
    s_mov_b64 exec, -1
    buffer_load_dwordx4 v[40:43], v8, s[68:71], s82 offen nt
    s_mov_b64 exec, s[88:89]
    buffer_load_dwordx4 v[44:47], v8, s[68:71], s83 offen nt
    s_mov_b64 exec, -1
    s_barrier
    v_mov_b32 v24, 0x62006200
    v_mov_b32 v25, 0x62006200
    v_mov_b32 v26, 0x62006200
    v_mov_b32 v27, 0x62006200
    v_add_u32 v9, 138240, v8
    ds_write_b128 v8, v[24:27] offset:7168
    ds_write_b128 v8, v[24:27] offset:13312
    s_mov_b32 s32, s26
    s_and_b32 s33, s27, 0xffff
    s_mov_b32 s34, 17829888
    s_mov_b32 s35, 0x00020000
    s_mul_i32 s31, s2, 18816
    s_add_u32 s31, s31, 12849152
    s_add_u32 s44, s26, s31
    s_addc_u32 s45, s27, 0
    s_and_b32 s45, s45, 0xffff
    s_mov_b32 s46, 18768
    s_mov_b32 s47, 0x00020000
    s_mov_b32 s52, 85599
    s_movk_i32 s54, -196
    s_movk_i32 s55, 2560
    v_mov_b32 v15, 1
    v_lshlrev_b32 v7, 3, v1
    s_waitcnt vmcnt(5)
    v_mul_u32_u24 v48, s52, v32
    v_lshrrev_b32 v48, 24, v48
    v_mad_i32_i24 v32, v48, s54, v32
    v_lshl_add_u32 v48, v48, 2, s55
    ds_add_rtn_u32 v52, v48, v15
    v_mul_u32_u24 v49, s52, v33
    v_lshrrev_b32 v49, 24, v49
    v_mad_i32_i24 v33, v49, s54, v33
    v_lshl_add_u32 v49, v49, 2, s55
    ds_add_rtn_u32 v53, v49, v15
    s_waitcnt vmcnt(4)
    s_mov_b64 exec, s[88:89]
    v_mul_u32_u24 v50, s52, v34
    v_lshrrev_b32 v50, 24, v50
    v_mad_i32_i24 v34, v50, s54, v34
    v_lshl_add_u32 v50, v50, 2, s55
    ds_add_rtn_u32 v54, v50, v15
    v_mul_u32_u24 v51, s52, v35
    v_lshrrev_b32 v51, 24, v51
    v_mad_i32_i24 v35, v51, s54, v35
    v_lshl_add_u32 v51, v51, 2, s55
    ds_add_rtn_u32 v55, v51, v15
    s_mov_b64 exec, 1
    ds_add_u32 v3, v15 offset:1536
    s_mov_b64 exec, -1
    s_waitcnt vmcnt(2)
    v_lshl_or_b32 v36, v32, 18, v36
    v_lshl_or_b32 v37, v33, 18, v37
    v_lshl_or_b32 v38, v34, 18, v38
    v_lshl_or_b32 v39, v35, 18, v39
kf_s1:
    ds_read_b32 v16, v3 offset:1536
    s_waitcnt lgkmcnt(0)
    v_readfirstlane_b32 s53, v16
    s_cmp_ge_u32 s53, 8
    s_cbranch_scc1 kf_s1_ok
    s_branch kf_s1
kf_s1_ok:
    ds_read_b64 v[24:25], v7 offset:2560
    s_waitcnt lgkmcnt(0)
    v_add_u32 v27, v24, v25
    s_nop 1
    v_add_u32_dpp v27, v27, v27 row_shr:1 row_mask:0xf bank_mask:0xf bound_ctrl:1
    s_nop 1
    v_add_u32_dpp v27, v27, v27 row_shr:2 row_mask:0xf bank_mask:0xf bound_ctrl:1
    s_nop 1
    v_add_u32_dpp v27, v27, v27 row_shr:4 row_mask:0xf bank_mask:0xf bound_ctrl:1
    s_nop 1
    v_add_u32_dpp v27, v27, v27 row_shr:8 row_mask:0xf bank_mask:0xf bound_ctrl:1
    s_nop 1
    v_add_u32_dpp v27, v27, v27 row_bcast:15 row_mask:0xa bank_mask:0xf
    s_nop 1
    v_add_u32_dpp v27, v27, v27 row_bcast:31 row_mask:0xc bank_mask:0xf
    v_sub_u32 v27, v27, v25
    v_sub_u32 v26, v27, v24
    ds_write_b64 v7, v[26:27] offset:3072
    ds_read_b32 v48, v48 offset:512
    ds_read_b32 v49, v49 offset:512
    s_mov_b64 exec, s[88:89]
    ds_read_b32 v50, v50 offset:512
    ds_read_b32 v51, v51 offset:512
    s_mov_b64 exec, -1
    v_lshl_or_b32 v24, v24, 16, v26
    v_lshl_or_b32 v25, v25, 16, v27
    v_or_b32 v24, 0x80000000, v24
    v_or_b32 v25, 0x80000000, v25
    s_mov_b32 s31, 138240
    s_mov_b32 s52, 144496
    s_waitcnt vmcnt(0)
    s_waitcnt lgkmcnt(3)
    v_add_u32 v48, v48, v52
    v_lshl_add_u32 v52, v48, 2, s31
    v_lshl_add_u32 v48, v48, 3, s52
    ds_write_b32 v52, v36
    ds_write_b64 v48, v[40:41]
    s_waitcnt lgkmcnt(4)
    v_add_u32 v49, v49, v53
    v_lshl_add_u32 v53, v49, 2, s31
    v_lshl_add_u32 v49, v49, 3, s52
    ds_write_b32 v53, v37
    ds_write_b64 v49, v[42:43]
    s_mov_b64 exec, s[88:89]
    s_waitcnt lgkmcnt(5)
    v_add_u32 v50, v50, v54
    v_lshl_add_u32 v54, v50, 2, s31
    v_lshl_add_u32 v50, v50, 3, s52
    ds_write_b32 v54, v38
    ds_write_b64 v50, v[44:45]
    s_waitcnt lgkmcnt(6)
    v_add_u32 v51, v51, v55
    v_lshl_add_u32 v55, v51, 2, s31
    v_lshl_add_u32 v51, v51, 3, s52
    ds_write_b32 v55, v39
    ds_write_b64 v51, v[46:47]
    s_mov_b64 exec, 1
    ds_add_u32 v3, v15 offset:1540
    s_mov_b64 exec, -1
kf_s2:
    ds_read_b32 v16, v3 offset:1540
    s_waitcnt lgkmcnt(0)
    v_readfirstlane_b32 s53, v16
    s_cmp_ge_u32 s53, 8
    s_cbranch_scc1 kf_s2_ok
    s_branch kf_s2
kf_s2_ok:
    ds_read_b128 v[32:35], v9 offset:0
    ds_read_b128 v[36:39], v9 offset:8192
    ds_read_b128 v[40:43], v9 offset:16384
    s_movk_i32 s52, 0
    s_waitcnt lgkmcnt(2)
    buffer_store_dwordx4 v[32:35], v8, s[44:47], s52 offen sc1
    s_movk_i32 s52, 8192
    s_waitcnt lgkmcnt(1)
    buffer_store_dwordx4 v[36:39], v8, s[44:47], s52 offen sc1
    s_movk_i32 s52, 16384
    s_waitcnt lgkmcnt(0)
    buffer_store_dwordx4 v[40:43], v8, s[44:47], s52 offen sc1
    s_mov_b64 exec, 1
    ds_add_u32 v3, v15 offset:1576
    s_mov_b64 exec, -1
    s_sub_u32 s54, s3, 8
    v_lshrrev_b32 v5, 1, v1
    v_lshl_add_u32 v4, v5, 3, s54
    v_lshlrev_b32 v7, 11, v1
    s_and_b32 s52, s2, 7
    s_lshl_b32 s52, s52, 5
    s_lshr_b32 s55, s2, 3
    s_add_u32 s52, s52, s55
    s_lshl_b32 s52, s52, 2
    v_lshlrev_b32 v6, 2, v5
    s_lshl_b32 s31, s29, 10
    s_lshl_b32 s55, s54, 7
    s_add_u32 s31, s31, s55
    s_add_u32 s52, s52, 17666048
    s_add_u32 s31, s31, 17666048
    v_mul_u32_u24 v4, 18816, v4
    v_add_u32 v4, 12849152, v4
    v_and_b32 v10, 7, v1
    v_lshlrev_b32 v9, 1, v10
    v_lshlrev_b32 v11, 4, v10
    v_lshlrev_b32 v10, 3, v10
    v_mov_b32 v14, 0x400040
    s_waitcnt vmcnt(0)
    s_mov_b64 exec, 1
    ds_add_rtn_u32 v18, v3, v15 offset:1544
    s_mov_b64 exec, -1
    s_waitcnt lgkmcnt(0)
    v_readfirstlane_b32 s55, v18
kf_zr:
    ds_read_b32 v16, v3 offset:1548
    s_waitcnt lgkmcnt(0)
    v_readfirstlane_b32 s53, v16
    s_cmp_ge_u32 s53, 1
    s_cbranch_scc1 kf_zr_ok
    s_sleep 1
    s_branch kf_zr
kf_zr_ok:
    s_cmp_lg_u32 s55, 7
    s_cbranch_scc1 kf_a4
    buffer_store_dword v24, v7, s[32:35], s52 offen sc1
    buffer_store_dword v25, v7, s[32:35], s52 offen offset:1024 sc1
kf_a4:
    s_mov_b32 s90, 32768
kf_po:
    s_load_dwordx16 s[56:71], s[26:27], s31 glc
    s_load_dwordx16 s[72:87], s[26:27], s31 offset:64 glc
    s_waitcnt lgkmcnt(0)
    s_and_b64 s[88:89], s[56:57], s[58:59]
    s_and_b64 s[88:89], s[88:89], s[60:61]
    s_and_b64 s[88:89], s[88:89], s[62:63]
    s_and_b64 s[88:89], s[88:89], s[64:65]
    s_and_b64 s[88:89], s[88:89], s[66:67]
    s_and_b64 s[88:89], s[88:89], s[68:69]
    s_and_b64 s[88:89], s[88:89], s[70:71]
    s_and_b64 s[88:89], s[88:89], s[72:73]
    s_and_b64 s[88:89], s[88:89], s[74:75]
    s_and_b64 s[88:89], s[88:89], s[76:77]
    s_and_b64 s[88:89], s[88:89], s[78:79]
    s_and_b64 s[88:89], s[88:89], s[80:81]
    s_and_b64 s[88:89], s[88:89], s[82:83]
    s_and_b64 s[88:89], s[88:89], s[84:85]
    s_and_b64 s[88:89], s[88:89], s[86:87]
    s_and_b32 s88, s88, s89
    s_cmp_lt_i32 s88, 0
    s_cbranch_scc1 kf_po_ok
    s_sleep 8
    s_sub_u32 s90, s90, 1
    s_cbranch_scc0 kf_po
kf_po_ok:
    v_writelane_b32 v5, s56, 0
    v_writelane_b32 v5, s57, 2
    v_writelane_b32 v5, s58, 4
    v_writelane_b32 v5, s59, 6
    v_writelane_b32 v5, s60, 8
    v_writelane_b32 v5, s61, 10
    v_writelane_b32 v5, s62, 12
    v_writelane_b32 v5, s63, 14
    v_writelane_b32 v5, s64, 16
    v_writelane_b32 v5, s65, 18
    v_writelane_b32 v5, s66, 20
    v_writelane_b32 v5, s67, 22
    v_writelane_b32 v5, s68, 24
    v_writelane_b32 v5, s69, 26
    v_writelane_b32 v5, s70, 28
    v_writelane_b32 v5, s71, 30
    v_writelane_b32 v5, s72, 32
    v_writelane_b32 v5, s73, 34
    v_writelane_b32 v5, s74, 36
    v_writelane_b32 v5, s75, 38
    v_writelane_b32 v5, s76, 40
    v_writelane_b32 v5, s77, 42
    v_writelane_b32 v5, s78, 44
    v_writelane_b32 v5, s79, 46
    v_writelane_b32 v5, s80, 48
    v_writelane_b32 v5, s81, 50
    v_writelane_b32 v5, s82, 52
    v_writelane_b32 v5, s83, 54
    v_writelane_b32 v5, s84, 56
    v_writelane_b32 v5, s85, 58
    v_writelane_b32 v5, s86, 60
    v_writelane_b32 v5, s87, 62
    s_nop 1
    v_mov_b32_dpp v5, v5 quad_perm:[0,0,2,2] row_mask:0xf bank_mask:0xf
    v_cmp_gt_i32 vcc, 0, v5
    s_nop 1
    v_cndmask_b32 v5, 0, v5, vcc
    v_bfe_u32 v6, v5, 16, 15
    v_and_b32 v5, 0xffff, v5
    v_lshl_add_u32 v7, v5, 2, v4
    v_lshl_add_u32 v8, v5, 3, v4
    s_movk_i32 s95, 6256
    v_and_b32 v5, 1, v1
    v_sub_u32_dpp v96, v6, v9 row_newbcast:0 row_mask:0xf bank_mask:0x3
    v_add_u32_dpp v100, v7, v10 row_newbcast:0 row_mask:0xf bank_mask:0x3
    v_add_u32_dpp v116, v8, v11 row_newbcast:0 row_mask:0xf bank_mask:0x3
    v_sub_u32_dpp v96, v6, v9 row_newbcast:2 row_mask:0xf bank_mask:0xc
    v_add_u32_dpp v100, v7, v10 row_newbcast:2 row_mask:0xf bank_mask:0xc
    v_add_u32_dpp v116, v8, v11 row_newbcast:2 row_mask:0xf bank_mask:0xc
    v_sub_u32_dpp v97, v6, v9 row_newbcast:4 row_mask:0xf bank_mask:0x3
    v_add_u32_dpp v101, v7, v10 row_newbcast:4 row_mask:0xf bank_mask:0x3
    v_add_u32_dpp v117, v8, v11 row_newbcast:4 row_mask:0xf bank_mask:0x3
    v_sub_u32_dpp v97, v6, v9 row_newbcast:6 row_mask:0xf bank_mask:0xc
    v_add_u32_dpp v101, v7, v10 row_newbcast:6 row_mask:0xf bank_mask:0xc
    v_add_u32_dpp v117, v8, v11 row_newbcast:6 row_mask:0xf bank_mask:0xc
    v_sub_u32_dpp v98, v6, v9 row_newbcast:8 row_mask:0xf bank_mask:0x3
    v_add_u32_dpp v102, v7, v10 row_newbcast:8 row_mask:0xf bank_mask:0x3
    v_add_u32_dpp v118, v8, v11 row_newbcast:8 row_mask:0xf bank_mask:0x3
    v_sub_u32_dpp v98, v6, v9 row_newbcast:10 row_mask:0xf bank_mask:0xc
    v_add_u32_dpp v102, v7, v10 row_newbcast:10 row_mask:0xf bank_mask:0xc
    v_add_u32_dpp v118, v8, v11 row_newbcast:10 row_mask:0xf bank_mask:0xc
    v_sub_u32_dpp v99, v6, v9 row_newbcast:12 row_mask:0xf bank_mask:0x3
    v_add_u32_dpp v103, v7, v10 row_newbcast:12 row_mask:0xf bank_mask:0x3
    v_add_u32_dpp v119, v8, v11 row_newbcast:12 row_mask:0xf bank_mask:0x3
    v_sub_u32_dpp v99, v6, v9 row_newbcast:14 row_mask:0xf bank_mask:0xc
    v_add_u32_dpp v103, v7, v10 row_newbcast:14 row_mask:0xf bank_mask:0xc
    v_add_u32_dpp v119, v8, v11 row_newbcast:14 row_mask:0xf bank_mask:0xc
    v_cmpx_lt_i32 vcc, 0, v96
    buffer_load_dwordx2 v[16:17], v100, s[32:35], 0 offen sc1
    s_mov_b64 exec, -1
    v_cmpx_lt_i32 vcc, 0, v97
    buffer_load_dwordx2 v[18:19], v101, s[32:35], 0 offen sc1
    s_mov_b64 exec, -1
    v_cmpx_lt_i32 vcc, 0, v98
    buffer_load_dwordx2 v[20:21], v102, s[32:35], 0 offen sc1
    s_mov_b64 exec, -1
    v_cmpx_lt_i32 vcc, 0, v99
    buffer_load_dwordx2 v[22:23], v103, s[32:35], 0 offen sc1
    s_mov_b64 exec, -1
    v_lshlrev_b32 v2, 2, v5
    v_sub_u32 v2, v6, v2
    v_lshl_add_u32 v7, v5, 4, v7
    v_lshl_add_u32 v8, v5, 5, v8
    v_cmpx_lt_i32 vcc, 16, v2
    buffer_load_dwordx4 v[40:43], v7, s[32:35], 0 offen offset:64 sc1
    v_cmpx_lt_i32 vcc, 24, v2
    buffer_load_dwordx4 v[44:47], v7, s[32:35], 0 offen offset:96 sc1
    v_cmpx_lt_i32 vcc, 32, v2
    buffer_load_dwordx4 v[48:51], v7, s[32:35], 0 offen offset:128 sc1
    s_mov_b64 exec, -1
    v_cmpx_lt_u32 vcc, 40, v6
    v_mov_b32 v12, 0x4000
    ds_write_b32 v3, v12 offset:1568
    s_mov_b64 exec, -1
    s_waitcnt vmcnt(6)
    v_cmpx_lt_i32 vcc, 0, v96
    v_lshrrev_b32 v12, 16, v16
    ds_add_u32 v12, v15
    v_cmpx_lt_i32 vcc, 1, v96
    v_lshrrev_b32 v12, 16, v17
    ds_add_u32 v12, v15
    s_mov_b64 exec, -1
    s_waitcnt vmcnt(5)
    v_cmpx_lt_i32 vcc, 0, v97
    v_lshrrev_b32 v12, 16, v18
    ds_add_u32 v12, v15
    v_cmpx_lt_i32 vcc, 1, v97
    v_lshrrev_b32 v12, 16, v19
    ds_add_u32 v12, v15
    s_mov_b64 exec, -1
    s_waitcnt vmcnt(4)
    v_cmpx_lt_i32 vcc, 0, v98
    v_lshrrev_b32 v12, 16, v20
    ds_add_u32 v12, v15
    v_cmpx_lt_i32 vcc, 1, v98
    v_lshrrev_b32 v12, 16, v21
    ds_add_u32 v12, v15
    s_mov_b64 exec, -1
    s_waitcnt vmcnt(3)
    v_cmpx_lt_i32 vcc, 0, v99
    v_lshrrev_b32 v12, 16, v22
    ds_add_u32 v12, v15
    v_cmpx_lt_i32 vcc, 1, v99
    v_lshrrev_b32 v12, 16, v23
    ds_add_u32 v12, v15
    s_mov_b64 exec, -1
    v_cmpx_lt_i32 vcc, 16, v2
    s_cbranch_execz kf_p1e
    s_waitcnt vmcnt(2)
    v_lshrrev_b32 v12, 16, v40
    ds_add_u32 v12, v15
    v_cmpx_lt_i32 vcc, 17, v2
    v_lshrrev_b32 v12, 16, v41
    ds_add_u32 v12, v15
    v_cmpx_lt_i32 vcc, 18, v2
    v_lshrrev_b32 v12, 16, v42
    ds_add_u32 v12, v15
    v_cmpx_lt_i32 vcc, 19, v2
    v_lshrrev_b32 v12, 16, v43
    ds_add_u32 v12, v15
    v_cmpx_lt_i32 vcc, 24, v2
    s_cbranch_execz kf_p1e
    s_waitcnt vmcnt(1)
    v_lshrrev_b32 v12, 16, v44
    ds_add_u32 v12, v15
    v_cmpx_lt_i32 vcc, 25, v2
    v_lshrrev_b32 v12, 16, v45
    ds_add_u32 v12, v15
    v_cmpx_lt_i32 vcc, 26, v2
    v_lshrrev_b32 v12, 16, v46
    ds_add_u32 v12, v15
    v_cmpx_lt_i32 vcc, 27, v2
    v_lshrrev_b32 v12, 16, v47
    ds_add_u32 v12, v15
    v_cmpx_lt_i32 vcc, 32, v2
    s_cbranch_execz kf_p1e
    s_waitcnt vmcnt(0)
    v_lshrrev_b32 v12, 16, v48
    ds_add_u32 v12, v15
    v_cmpx_lt_i32 vcc, 33, v2
    v_lshrrev_b32 v12, 16, v49
    ds_add_u32 v12, v15
    v_cmpx_lt_i32 vcc, 34, v2
    v_lshrrev_b32 v12, 16, v50
    ds_add_u32 v12, v15
    v_cmpx_lt_i32 vcc, 35, v2
    v_lshrrev_b32 v12, 16, v51
    ds_add_u32 v12, v15
kf_p1e:
    s_mov_b64 exec, -1
    s_mov_b64 exec, 1
    ds_add_u32 v3, v15 offset:1556
    s_mov_b64 exec, -1
    s_setprio 0
    v_cmpx_lt_i32 vcc, 0, v96
    buffer_load_dwordx4 v[24:27], v116, s[32:35], s95 offen sc1
    s_mov_b64 exec, -1
    v_cmpx_lt_i32 vcc, 0, v97
    buffer_load_dwordx4 v[28:31], v117, s[32:35], s95 offen sc1
    s_mov_b64 exec, -1
    v_cmpx_lt_i32 vcc, 0, v98
    buffer_load_dwordx4 v[32:35], v118, s[32:35], s95 offen sc1
    s_mov_b64 exec, -1
    v_cmpx_lt_i32 vcc, 0, v99
    buffer_load_dwordx4 v[36:39], v119, s[32:35], s95 offen sc1
    s_mov_b64 exec, -1
    v_cmpx_lt_i32 vcc, 16, v2
    buffer_load_dwordx4 v[52:55], v8, s[32:35], s95 offen offset:128 sc1
    v_cmpx_lt_i32 vcc, 18, v2
    buffer_load_dwordx4 v[56:59], v8, s[32:35], s95 offen offset:144 sc1
    v_cmpx_lt_i32 vcc, 24, v2
    buffer_load_dwordx4 v[60:63], v8, s[32:35], s95 offen offset:192 sc1
    v_cmpx_lt_i32 vcc, 26, v2
    buffer_load_dwordx4 v[64:67], v8, s[32:35], s95 offen offset:208 sc1
    v_cmpx_lt_i32 vcc, 32, v2
    buffer_load_dwordx4 v[68:71], v8, s[32:35], s95 offen offset:256 sc1
    v_cmpx_lt_i32 vcc, 34, v2
    buffer_load_dwordx4 v[72:75], v8, s[32:35], s95 offen offset:272 sc1
    s_mov_b64 exec, -1
    s_setprio 3
    s_mov_b64 exec, 1
    ds_add_u32 v3, v15 offset:1572
    s_mov_b64 exec, -1
kf_rp:
    ds_read_b32 v12, v3 offset:1560
    s_waitcnt lgkmcnt(0)
    v_readfirstlane_b32 s53, v12
    s_cmp_ge_u32 s53, 1
    s_cbranch_scc1 kf_rp_ok
    s_sleep 1
    s_branch kf_rp
kf_rp_ok:
    s_cmp_eq_u32 s53, 2
    s_cbranch_scc1 kf_rs
    s_movk_i32 s92, 25096
    v_cmpx_lt_i32 vcc, 0, v96
    v_lshrrev_b32 v12, 16, v16
    ds_add_rtn_u32 v76, v12, v14
    v_cmpx_lt_i32 vcc, 1, v96
    v_lshrrev_b32 v12, 16, v17
    ds_add_rtn_u32 v77, v12, v14
    s_mov_b64 exec, -1
    v_cmpx_lt_i32 vcc, 0, v97
    v_lshrrev_b32 v12, 16, v18
    ds_add_rtn_u32 v78, v12, v14
    v_cmpx_lt_i32 vcc, 1, v97
    v_lshrrev_b32 v12, 16, v19
    ds_add_rtn_u32 v79, v12, v14
    s_mov_b64 exec, -1
    v_cmpx_lt_i32 vcc, 0, v98
    v_lshrrev_b32 v12, 16, v20
    ds_add_rtn_u32 v80, v12, v14
    v_cmpx_lt_i32 vcc, 1, v98
    v_lshrrev_b32 v12, 16, v21
    ds_add_rtn_u32 v81, v12, v14
    s_mov_b64 exec, -1
    v_cmpx_lt_i32 vcc, 0, v99
    v_lshrrev_b32 v12, 16, v22
    ds_add_rtn_u32 v82, v12, v14
    v_cmpx_lt_i32 vcc, 1, v99
    v_lshrrev_b32 v12, 16, v23
    ds_add_rtn_u32 v83, v12, v14
    s_mov_b64 exec, -1
    v_cmpx_lt_i32 vcc, 16, v2
    s_cbranch_execz kf_p5a
    v_lshrrev_b32 v12, 16, v40
    ds_add_rtn_u32 v84, v12, v14
    v_cmpx_lt_i32 vcc, 17, v2
    v_lshrrev_b32 v12, 16, v41
    ds_add_rtn_u32 v85, v12, v14
    v_cmpx_lt_i32 vcc, 18, v2
    v_lshrrev_b32 v12, 16, v42
    ds_add_rtn_u32 v86, v12, v14
    v_cmpx_lt_i32 vcc, 19, v2
    v_lshrrev_b32 v12, 16, v43
    ds_add_rtn_u32 v87, v12, v14
    v_cmpx_lt_i32 vcc, 24, v2
    s_cbranch_execz kf_p5a
    v_lshrrev_b32 v12, 16, v44
    ds_add_rtn_u32 v88, v12, v14
    v_cmpx_lt_i32 vcc, 25, v2
    v_lshrrev_b32 v12, 16, v45
    ds_add_rtn_u32 v89, v12, v14
    v_cmpx_lt_i32 vcc, 26, v2
    v_lshrrev_b32 v12, 16, v46
    ds_add_rtn_u32 v90, v12, v14
    v_cmpx_lt_i32 vcc, 27, v2
    v_lshrrev_b32 v12, 16, v47
    ds_add_rtn_u32 v91, v12, v14
    v_cmpx_lt_i32 vcc, 32, v2
    s_cbranch_execz kf_p5a
    v_lshrrev_b32 v12, 16, v48
    ds_add_rtn_u32 v92, v12, v14
    v_cmpx_lt_i32 vcc, 33, v2
    v_lshrrev_b32 v12, 16, v49
    ds_add_rtn_u32 v93, v12, v14
    v_cmpx_lt_i32 vcc, 34, v2
    v_lshrrev_b32 v12, 16, v50
    ds_add_rtn_u32 v94, v12, v14
    v_cmpx_lt_i32 vcc, 35, v2
    v_lshrrev_b32 v12, 16, v51
    ds_add_rtn_u32 v95, v12, v14
kf_p5a:
    s_mov_b64 exec, -1
    s_waitcnt lgkmcnt(0)
    v_cmpx_lt_i32 vcc, 0, v96
    v_bfe_u32 v12, v76, 2, 14
    v_lshrrev_b32 v13, 18, v76
    ds_write_b16 v12, v16 offset:7168
    v_add_u32 v16, s92, v16
    ds_write_b16 v13, v16 offset:7168
    v_cmpx_lt_i32 vcc, 1, v96
    v_bfe_u32 v12, v77, 2, 14
    v_lshrrev_b32 v13, 18, v77
    ds_write_b16 v12, v17 offset:7168
    v_add_u32 v17, s92, v17
    ds_write_b16 v13, v17 offset:7168
    s_mov_b64 exec, -1
    v_cmpx_lt_i32 vcc, 0, v97
    v_bfe_u32 v12, v78, 2, 14
    v_lshrrev_b32 v13, 18, v78
    ds_write_b16 v12, v18 offset:7168
    v_add_u32 v18, s92, v18
    ds_write_b16 v13, v18 offset:7168
    v_cmpx_lt_i32 vcc, 1, v97
    v_bfe_u32 v12, v79, 2, 14
    v_lshrrev_b32 v13, 18, v79
    ds_write_b16 v12, v19 offset:7168
    v_add_u32 v19, s92, v19
    ds_write_b16 v13, v19 offset:7168
    s_mov_b64 exec, -1
    v_cmpx_lt_i32 vcc, 0, v98
    v_bfe_u32 v12, v80, 2, 14
    v_lshrrev_b32 v13, 18, v80
    ds_write_b16 v12, v20 offset:7168
    v_add_u32 v20, s92, v20
    ds_write_b16 v13, v20 offset:7168
    v_cmpx_lt_i32 vcc, 1, v98
    v_bfe_u32 v12, v81, 2, 14
    v_lshrrev_b32 v13, 18, v81
    ds_write_b16 v12, v21 offset:7168
    v_add_u32 v21, s92, v21
    ds_write_b16 v13, v21 offset:7168
    s_mov_b64 exec, -1
    v_cmpx_lt_i32 vcc, 0, v99
    v_bfe_u32 v12, v82, 2, 14
    v_lshrrev_b32 v13, 18, v82
    ds_write_b16 v12, v22 offset:7168
    v_add_u32 v22, s92, v22
    ds_write_b16 v13, v22 offset:7168
    v_cmpx_lt_i32 vcc, 1, v99
    v_bfe_u32 v12, v83, 2, 14
    v_lshrrev_b32 v13, 18, v83
    ds_write_b16 v12, v23 offset:7168
    v_add_u32 v23, s92, v23
    ds_write_b16 v13, v23 offset:7168
    s_mov_b64 exec, -1
    v_cmpx_lt_i32 vcc, 16, v2
    s_cbranch_execz kf_p5b
    v_bfe_u32 v12, v84, 2, 14
    v_lshrrev_b32 v13, 18, v84
    ds_write_b16 v12, v40 offset:7168
    v_add_u32 v40, s92, v40
    ds_write_b16 v13, v40 offset:7168
    v_cmpx_lt_i32 vcc, 17, v2
    v_bfe_u32 v12, v85, 2, 14
    v_lshrrev_b32 v13, 18, v85
    ds_write_b16 v12, v41 offset:7168
    v_add_u32 v41, s92, v41
    ds_write_b16 v13, v41 offset:7168
    v_cmpx_lt_i32 vcc, 18, v2
    v_bfe_u32 v12, v86, 2, 14
    v_lshrrev_b32 v13, 18, v86
    ds_write_b16 v12, v42 offset:7168
    v_add_u32 v42, s92, v42
    ds_write_b16 v13, v42 offset:7168
    v_cmpx_lt_i32 vcc, 19, v2
    v_bfe_u32 v12, v87, 2, 14
    v_lshrrev_b32 v13, 18, v87
    ds_write_b16 v12, v43 offset:7168
    v_add_u32 v43, s92, v43
    ds_write_b16 v13, v43 offset:7168
    v_cmpx_lt_i32 vcc, 24, v2
    s_cbranch_execz kf_p5b
    v_bfe_u32 v12, v88, 2, 14
    v_lshrrev_b32 v13, 18, v88
    ds_write_b16 v12, v44 offset:7168
    v_add_u32 v44, s92, v44
    ds_write_b16 v13, v44 offset:7168
    v_cmpx_lt_i32 vcc, 25, v2
    v_bfe_u32 v12, v89, 2, 14
    v_lshrrev_b32 v13, 18, v89
    ds_write_b16 v12, v45 offset:7168
    v_add_u32 v45, s92, v45
    ds_write_b16 v13, v45 offset:7168
    v_cmpx_lt_i32 vcc, 26, v2
    v_bfe_u32 v12, v90, 2, 14
    v_lshrrev_b32 v13, 18, v90
    ds_write_b16 v12, v46 offset:7168
    v_add_u32 v46, s92, v46
    ds_write_b16 v13, v46 offset:7168
    v_cmpx_lt_i32 vcc, 27, v2
    v_bfe_u32 v12, v91, 2, 14
    v_lshrrev_b32 v13, 18, v91
    ds_write_b16 v12, v47 offset:7168
    v_add_u32 v47, s92, v47
    ds_write_b16 v13, v47 offset:7168
    v_cmpx_lt_i32 vcc, 32, v2
    s_cbranch_execz kf_p5b
    v_bfe_u32 v12, v92, 2, 14
    v_lshrrev_b32 v13, 18, v92
    ds_write_b16 v12, v48 offset:7168
    v_add_u32 v48, s92, v48
    ds_write_b16 v13, v48 offset:7168
    v_cmpx_lt_i32 vcc, 33, v2
    v_bfe_u32 v12, v93, 2, 14
    v_lshrrev_b32 v13, 18, v93
    ds_write_b16 v12, v49 offset:7168
    v_add_u32 v49, s92, v49
    ds_write_b16 v13, v49 offset:7168
    v_cmpx_lt_i32 vcc, 34, v2
    v_bfe_u32 v12, v94, 2, 14
    v_lshrrev_b32 v13, 18, v94
    ds_write_b16 v12, v50 offset:7168
    v_add_u32 v50, s92, v50
    ds_write_b16 v13, v50 offset:7168
    v_cmpx_lt_i32 vcc, 35, v2
    v_bfe_u32 v12, v95, 2, 14
    v_lshrrev_b32 v13, 18, v95
    ds_write_b16 v12, v51 offset:7168
    v_add_u32 v51, s92, v51
    ds_write_b16 v13, v51 offset:7168
kf_p5b:
    s_mov_b64 exec, -1
    s_mov_b32 s91, s53
    s_lshl_b32 s95, s3, 4
    v_mov_b32 v14, s95
    v_lshlrev_b32 v15, 4, v1
    ds_read_b128 v[124:127], v14 offset:3712
    ds_read_b128 v[4:7], v15 offset:4096
    ds_read_b128 v[104:107], v15 offset:5120
    v_and_b32 v14, 15, v1
    v_lshrrev_b32 v15, 4, v1
    v_lshlrev_b32 v15, 2, v15
    v_sub_u32 v14, v14, v15
    v_mov_b32 v15, 0x3f80
    v_cmp_eq_u32 vcc, 0, v14
    s_nop 1
    v_cndmask_b32 v8, 0, v15, vcc
    v_cmp_eq_u32 vcc, 1, v14
    s_nop 1
    v_cndmask_b32 v9, 0, v15, vcc
    v_cmp_eq_u32 vcc, 2, v14
    s_nop 1
    v_cndmask_b32 v10, 0, v15, vcc
    v_cmp_eq_u32 vcc, 3, v14
    s_nop 1
    v_cndmask_b32 v11, 0, v15, vcc
    s_add_u32 s36, s26, s30
    s_addc_u32 s37, s27, 0
    s_and_b32 s37, s37, 0xffff
    s_or_b32 s37, s37, 8388608
    s_mov_b32 s38, 50192
    s_mov_b32 s39, 0x00020000
    s_mul_i32 s31, s29, 50176
    s_add_u32 s46, s31, 50176
    s_min_u32 s46, s46, 6400000
    s_mov_b32 s44, s22
    s_and_b32 s45, s23, 0xffff
    s_mov_b32 s47, 0x00020000
    s_add_u32 s31, s31, s94
    v_lshrrev_b32 v14, 3, v1
    v_lshlrev_b32 v15, 2, v14
    s_waitcnt lgkmcnt(2)
    v_bfe_u32 v112, v124, 24, 5
    v_lshl_add_u32 v112, v112, 5, v15
    ds_read_b32 v112, v112 offset:1600
    v_bfe_u32 v113, v125, 24, 5
    v_lshl_add_u32 v113, v113, 5, v15
    ds_read_b32 v113, v113 offset:1600
    v_bfe_u32 v114, v126, 24, 5
    v_lshl_add_u32 v114, v114, 5, v15
    ds_read_b32 v114, v114 offset:1600
    v_bfe_u32 v115, v127, 24, 5
    v_lshl_add_u32 v115, v115, 5, v15
    ds_read_b32 v115, v115 offset:1600
    v_readfirstlane_b32 s87, v124
    v_readfirstlane_b32 s88, v125
    v_readfirstlane_b32 s89, v126
    v_readfirstlane_b32 s90, v127
    s_and_b32 s86, s87, 0xfff
    s_lshl_b32 s95, s86, 4
    s_add_u32 s95, s95, 7168
    v_lshl_add_u32 v12, v14, 1, s95
    s_lshl_b32 s95, s86, 6
    s_add_u32 s95, s95, 21504
    v_and_b32 v13, 12, v1
    v_lshl_add_u32 v13, v13, 2, s95
    s_lshr_b32 s72, s87, 29
    s_bfe_u32 s87, s87, 0xc000c
    s_lshr_b32 s73, s88, 29
    s_bfe_u32 s88, s88, 0xc000c
    s_lshr_b32 s74, s89, 29
    s_bfe_u32 s89, s89, 0xc000c
    s_lshr_b32 s75, s90, 29
    s_bfe_u32 s90, s90, 0xc000c
    v_and_b32 v14, 7, v1
    v_lshlrev_b32 v15, 3, v14
    s_mov_b32 s76, 0x22221111
    s_mov_b32 s77, 0x88884444
    s_mov_b32 s78, 1.0
    s_mov_b32 s79, 1.0
    s_sub_u32 s86, s87, 2
    s_mul_i32 s95, s72, 25600
    s_add_u32 s95, s95, 87040
    s_lshl_b32 s93, s72, 6
    s_waitcnt lgkmcnt(3)
    v_xor_b32 v124, v112, v14
    v_and_b32 v124, 7, v124
    v_lshl_add_u32 v124, v124, 4, s95
    v_lshl_add_u32 v124, v112, 7, v124
    v_and_b32 v108, 7, v112
    v_lshlrev_b32 v108, 4, v108
    v_lshl_add_u32 v108, v112, 7, v108
    v_lshl_add_u32 v112, v112, 8, v15
    v_xor_b32 v108, v108, v15
    v_or_b32 v112, s93, v112
    v_xor_b32 v108, s93, v108
    v_add_u32 v108, 138240, v108
    s_mul_i32 s95, s73, 25600
    s_add_u32 s95, s95, 87040
    s_lshl_b32 s93, s73, 6
    s_waitcnt lgkmcnt(2)
    v_xor_b32 v125, v113, v14
    v_and_b32 v125, 7, v125
    v_lshl_add_u32 v125, v125, 4, s95
    v_lshl_add_u32 v125, v113, 7, v125
    v_and_b32 v109, 7, v113
    v_lshlrev_b32 v109, 4, v109
    v_lshl_add_u32 v109, v113, 7, v109
    v_lshl_add_u32 v113, v113, 8, v15
    v_xor_b32 v109, v109, v15
    v_or_b32 v113, s93, v113
    v_xor_b32 v109, s93, v109
    v_add_u32 v109, 138240, v109
    s_mul_i32 s95, s74, 25600
    s_add_u32 s95, s95, 87040
    s_lshl_b32 s93, s74, 6
    s_waitcnt lgkmcnt(1)
    v_xor_b32 v126, v114, v14
    v_and_b32 v126, 7, v126
    v_lshl_add_u32 v126, v126, 4, s95
    v_lshl_add_u32 v126, v114, 7, v126
    v_and_b32 v110, 7, v114
    v_lshlrev_b32 v110, 4, v110
    v_lshl_add_u32 v110, v114, 7, v110
    v_lshl_add_u32 v114, v114, 8, v15
    v_xor_b32 v110, v110, v15
    v_or_b32 v114, s93, v114
    v_xor_b32 v110, s93, v110
    v_add_u32 v110, 138240, v110
    s_mul_i32 s95, s75, 25600
    s_add_u32 s95, s95, 87040
    s_lshl_b32 s93, s75, 6
    s_waitcnt lgkmcnt(0)
    v_xor_b32 v127, v115, v14
    v_and_b32 v127, 7, v127
    v_lshl_add_u32 v127, v127, 4, s95
    v_lshl_add_u32 v127, v115, 7, v127
    v_and_b32 v111, 7, v115
    v_lshlrev_b32 v111, 4, v111
    v_lshl_add_u32 v111, v115, 7, v111
    v_lshl_add_u32 v115, v115, 8, v15
    v_xor_b32 v111, v111, v15
    v_or_b32 v115, s93, v115
    v_xor_b32 v111, s93, v111
    v_add_u32 v111, 138240, v111
kf_ez:
    ds_read_b32 v14, v3 offset:1584
    s_waitcnt lgkmcnt(0)
    v_readfirstlane_b32 s53, v14
    s_cmp_ge_u32 s53, 7
    s_cbranch_scc1 kf_ez_ok
    s_sleep 1
    s_branch kf_ez
kf_ez_ok:
    s_waitcnt vmcnt(9)
    v_cmpx_lt_i32 vcc, 0, v96
    v_and_b32 v14, 0xffff, v76
    v_lshrrev_b32 v15, 16, v76
    ds_write_b64 v14, v[24:25] offset:21504
    ds_write_b64 v15, v[24:25] offset:21504
    v_cmpx_lt_i32 vcc, 1, v96
    v_and_b32 v14, 0xffff, v77
    v_lshrrev_b32 v15, 16, v77
    ds_write_b64 v14, v[26:27] offset:21504
    ds_write_b64 v15, v[26:27] offset:21504
    s_mov_b64 exec, -1
    s_waitcnt vmcnt(8)
    v_cmpx_lt_i32 vcc, 0, v97
    v_and_b32 v14, 0xffff, v78
    v_lshrrev_b32 v15, 16, v78
    ds_write_b64 v14, v[28:29] offset:21504
    ds_write_b64 v15, v[28:29] offset:21504
    v_cmpx_lt_i32 vcc, 1, v97
    v_and_b32 v14, 0xffff, v79
    v_lshrrev_b32 v15, 16, v79
    ds_write_b64 v14, v[30:31] offset:21504
    ds_write_b64 v15, v[30:31] offset:21504
    s_mov_b64 exec, -1
    s_waitcnt vmcnt(7)
    v_cmpx_lt_i32 vcc, 0, v98
    v_and_b32 v14, 0xffff, v80
    v_lshrrev_b32 v15, 16, v80
    ds_write_b64 v14, v[32:33] offset:21504
    ds_write_b64 v15, v[32:33] offset:21504
    v_cmpx_lt_i32 vcc, 1, v98
    v_and_b32 v14, 0xffff, v81
    v_lshrrev_b32 v15, 16, v81
    ds_write_b64 v14, v[34:35] offset:21504
    ds_write_b64 v15, v[34:35] offset:21504
    s_mov_b64 exec, -1
    s_waitcnt vmcnt(6)
    v_cmpx_lt_i32 vcc, 0, v99
    v_and_b32 v14, 0xffff, v82
    v_lshrrev_b32 v15, 16, v82
    ds_write_b64 v14, v[36:37] offset:21504
    ds_write_b64 v15, v[36:37] offset:21504
    v_cmpx_lt_i32 vcc, 1, v99
    v_and_b32 v14, 0xffff, v83
    v_lshrrev_b32 v15, 16, v83
    ds_write_b64 v14, v[38:39] offset:21504
    ds_write_b64 v15, v[38:39] offset:21504
    s_mov_b64 exec, -1
    v_cmpx_lt_i32 vcc, 16, v2
    s_cbranch_execz kf_p5e
    s_waitcnt vmcnt(4)
    v_and_b32 v14, 0xffff, v84
    v_lshrrev_b32 v15, 16, v84
    ds_write_b64 v14, v[52:53] offset:21504
    ds_write_b64 v15, v[52:53] offset:21504
    v_cmpx_lt_i32 vcc, 17, v2
    v_and_b32 v14, 0xffff, v85
    v_lshrrev_b32 v15, 16, v85
    ds_write_b64 v14, v[54:55] offset:21504
    ds_write_b64 v15, v[54:55] offset:21504
    v_cmpx_lt_i32 vcc, 18, v2
    v_and_b32 v14, 0xffff, v86
    v_lshrrev_b32 v15, 16, v86
    ds_write_b64 v14, v[56:57] offset:21504
    ds_write_b64 v15, v[56:57] offset:21504
    v_cmpx_lt_i32 vcc, 19, v2
    v_and_b32 v14, 0xffff, v87
    v_lshrrev_b32 v15, 16, v87
    ds_write_b64 v14, v[58:59] offset:21504
    ds_write_b64 v15, v[58:59] offset:21504
    v_cmpx_lt_i32 vcc, 24, v2
    s_cbranch_execz kf_p5e
    s_waitcnt vmcnt(2)
    v_and_b32 v14, 0xffff, v88
    v_lshrrev_b32 v15, 16, v88
    ds_write_b64 v14, v[60:61] offset:21504
    ds_write_b64 v15, v[60:61] offset:21504
    v_cmpx_lt_i32 vcc, 25, v2
    v_and_b32 v14, 0xffff, v89
    v_lshrrev_b32 v15, 16, v89
    ds_write_b64 v14, v[62:63] offset:21504
    ds_write_b64 v15, v[62:63] offset:21504
    v_cmpx_lt_i32 vcc, 26, v2
    v_and_b32 v14, 0xffff, v90
    v_lshrrev_b32 v15, 16, v90
    ds_write_b64 v14, v[64:65] offset:21504
    ds_write_b64 v15, v[64:65] offset:21504
    v_cmpx_lt_i32 vcc, 27, v2
    v_and_b32 v14, 0xffff, v91
    v_lshrrev_b32 v15, 16, v91
    ds_write_b64 v14, v[66:67] offset:21504
    ds_write_b64 v15, v[66:67] offset:21504
    v_cmpx_lt_i32 vcc, 32, v2
    s_cbranch_execz kf_p5e
    s_waitcnt vmcnt(0)
    v_and_b32 v14, 0xffff, v92
    v_lshrrev_b32 v15, 16, v92
    ds_write_b64 v14, v[68:69] offset:21504
    ds_write_b64 v15, v[68:69] offset:21504
    v_cmpx_lt_i32 vcc, 33, v2
    v_and_b32 v14, 0xffff, v93
    v_lshrrev_b32 v15, 16, v93
    ds_write_b64 v14, v[70:71] offset:21504
    ds_write_b64 v15, v[70:71] offset:21504
    v_cmpx_lt_i32 vcc, 34, v2
    v_and_b32 v14, 0xffff, v94
    v_lshrrev_b32 v15, 16, v94
    ds_write_b64 v14, v[72:73] offset:21504
    ds_write_b64 v15, v[72:73] offset:21504
    v_cmpx_lt_i32 vcc, 35, v2
    v_and_b32 v14, 0xffff, v95
    v_lshrrev_b32 v15, 16, v95
    ds_write_b64 v14, v[74:75] offset:21504
    ds_write_b64 v15, v[74:75] offset:21504
kf_p5e:
    s_mov_b64 exec, -1
    s_branch kf_join
kf_rs:
    s_mov_b32 s91, s53
    s_lshl_b32 s95, s3, 4
    v_mov_b32 v14, s95
    v_lshlrev_b32 v15, 4, v1
    ds_read_b128 v[124:127], v14 offset:3712
    ds_read_b128 v[4:7], v15 offset:4096
    ds_read_b128 v[104:107], v15 offset:5120
    v_and_b32 v14, 15, v1
    v_lshrrev_b32 v15, 4, v1
    v_lshlrev_b32 v15, 2, v15
    v_sub_u32 v14, v14, v15
    v_mov_b32 v15, 0x3f80
    v_cmp_eq_u32 vcc, 0, v14
    s_nop 1
    v_cndmask_b32 v8, 0, v15, vcc
    v_cmp_eq_u32 vcc, 1, v14
    s_nop 1
    v_cndmask_b32 v9, 0, v15, vcc
    v_cmp_eq_u32 vcc, 2, v14
    s_nop 1
    v_cndmask_b32 v10, 0, v15, vcc
    v_cmp_eq_u32 vcc, 3, v14
    s_nop 1
    v_cndmask_b32 v11, 0, v15, vcc
    s_add_u32 s36, s26, s30
    s_addc_u32 s37, s27, 0
    s_and_b32 s37, s37, 0xffff
    s_or_b32 s37, s37, 8388608
    s_mov_b32 s38, 50192
    s_mov_b32 s39, 0x00020000
    s_mul_i32 s31, s29, 50176
    s_add_u32 s46, s31, 50176
    s_min_u32 s46, s46, 6400000
    s_mov_b32 s44, s22
    s_and_b32 s45, s23, 0xffff
    s_mov_b32 s47, 0x00020000
    s_add_u32 s31, s31, s94
    v_lshrrev_b32 v14, 3, v1
    v_lshlrev_b32 v15, 2, v14
    s_waitcnt lgkmcnt(2)
    v_bfe_u32 v112, v124, 24, 5
    v_lshl_add_u32 v112, v112, 5, v15
    ds_read_b32 v112, v112 offset:1600
    v_bfe_u32 v113, v125, 24, 5
    v_lshl_add_u32 v113, v113, 5, v15
    ds_read_b32 v113, v113 offset:1600
    v_bfe_u32 v114, v126, 24, 5
    v_lshl_add_u32 v114, v114, 5, v15
    ds_read_b32 v114, v114 offset:1600
    v_bfe_u32 v115, v127, 24, 5
    v_lshl_add_u32 v115, v115, 5, v15
    ds_read_b32 v115, v115 offset:1600
    v_readfirstlane_b32 s87, v124
    v_readfirstlane_b32 s88, v125
    v_readfirstlane_b32 s89, v126
    v_readfirstlane_b32 s90, v127
    s_and_b32 s86, s87, 0xfff
    s_lshl_b32 s95, s86, 4
    s_add_u32 s95, s95, 7168
    v_lshl_add_u32 v12, v14, 1, s95
    s_lshl_b32 s95, s86, 6
    s_add_u32 s95, s95, 21504
    v_and_b32 v13, 12, v1
    v_lshl_add_u32 v13, v13, 2, s95
    s_lshr_b32 s72, s87, 29
    s_bfe_u32 s87, s87, 0xc000c
    s_lshr_b32 s73, s88, 29
    s_bfe_u32 s88, s88, 0xc000c
    s_lshr_b32 s74, s89, 29
    s_bfe_u32 s89, s89, 0xc000c
    s_lshr_b32 s75, s90, 29
    s_bfe_u32 s90, s90, 0xc000c
    v_and_b32 v14, 7, v1
    v_lshlrev_b32 v15, 3, v14
    s_mov_b32 s76, 0x22221111
    s_mov_b32 s77, 0x88884444
    s_mov_b32 s78, 1.0
    s_mov_b32 s79, 1.0
    s_sub_u32 s86, s87, 2
    s_mul_i32 s95, s72, 25600
    s_add_u32 s95, s95, 87040
    s_lshl_b32 s93, s72, 6
    s_waitcnt lgkmcnt(3)
    v_xor_b32 v124, v112, v14
    v_and_b32 v124, 7, v124
    v_lshl_add_u32 v124, v124, 4, s95
    v_lshl_add_u32 v124, v112, 7, v124
    v_and_b32 v108, 7, v112
    v_lshlrev_b32 v108, 4, v108
    v_lshl_add_u32 v108, v112, 7, v108
    v_lshl_add_u32 v112, v112, 8, v15
    v_xor_b32 v108, v108, v15
    v_or_b32 v112, s93, v112
    v_xor_b32 v108, s93, v108
    v_add_u32 v108, 138240, v108
    s_mul_i32 s95, s73, 25600
    s_add_u32 s95, s95, 87040
    s_lshl_b32 s93, s73, 6
    s_waitcnt lgkmcnt(2)
    v_xor_b32 v125, v113, v14
    v_and_b32 v125, 7, v125
    v_lshl_add_u32 v125, v125, 4, s95
    v_lshl_add_u32 v125, v113, 7, v125
    v_and_b32 v109, 7, v113
    v_lshlrev_b32 v109, 4, v109
    v_lshl_add_u32 v109, v113, 7, v109
    v_lshl_add_u32 v113, v113, 8, v15
    v_xor_b32 v109, v109, v15
    v_or_b32 v113, s93, v113
    v_xor_b32 v109, s93, v109
    v_add_u32 v109, 138240, v109
    s_mul_i32 s95, s74, 25600
    s_add_u32 s95, s95, 87040
    s_lshl_b32 s93, s74, 6
    s_waitcnt lgkmcnt(1)
    v_xor_b32 v126, v114, v14
    v_and_b32 v126, 7, v126
    v_lshl_add_u32 v126, v126, 4, s95
    v_lshl_add_u32 v126, v114, 7, v126
    v_and_b32 v110, 7, v114
    v_lshlrev_b32 v110, 4, v110
    v_lshl_add_u32 v110, v114, 7, v110
    v_lshl_add_u32 v114, v114, 8, v15
    v_xor_b32 v110, v110, v15
    v_or_b32 v114, s93, v114
    v_xor_b32 v110, s93, v110
    v_add_u32 v110, 138240, v110
    s_mul_i32 s95, s75, 25600
    s_add_u32 s95, s95, 87040
    s_lshl_b32 s93, s75, 6
    s_waitcnt lgkmcnt(0)
    v_xor_b32 v127, v115, v14
    v_and_b32 v127, 7, v127
    v_lshl_add_u32 v127, v127, 4, s95
    v_lshl_add_u32 v127, v115, 7, v127
    v_and_b32 v111, 7, v115
    v_lshlrev_b32 v111, 4, v111
    v_lshl_add_u32 v111, v115, 7, v111
    v_lshl_add_u32 v115, v115, 8, v15
    v_xor_b32 v111, v111, v15
    v_or_b32 v115, s93, v115
    v_xor_b32 v111, s93, v111
    v_add_u32 v111, 138240, v111
kf_join:
    s_getpc_b64 s[84:85]
kf_pc:
    s_add_u32 s84, s84, kf_evA0-kf_pc
    s_addc_u32 s85, s85, 0
    s_mov_b32 s80, 0x358637bd
    s_mov_b32 s81, 0x358637bd
    s_cmp_eq_u32 s91, 2
    s_waitcnt lgkmcnt(0)
    s_barrier
    s_cbranch_scc1 kf_slow
    s_setprio 3
    s_add_u32 s92, s87, s88
    s_add_u32 s93, s89, s90
    s_add_u32 s92, s92, s93
    s_sub_i32 s92, s92, 30
    s_mov_b32 s93, 2
    ds_read_u16 v84, v12 offset:0
    ds_read_u16 v85, v12 offset:16
    ds_read_u16 v86, v12 offset:32
    ds_read_u16 v87, v12 offset:48
    ds_read_u16 v88, v12 offset:64
    ds_read_u16 v89, v12 offset:80
    ds_read_u16 v90, v12 offset:96
    v_mov_b32 v52, 0
    v_mov_b32 v53, 0
    v_mov_b32 v54, 0
    v_mov_b32 v55, 0
    v_mov_b32 v56, 0
    v_mov_b32 v57, 0
    v_mov_b32 v58, 0
    v_mov_b32 v59, 0
    v_and_b32 v49, 7, v1
    v_lshlrev_b32 v49, 4, v49
    v_mov_b32 v51, v49
    s_mov_b64 exec, s[76:77]
    ds_read_b128 v[52:55], v13
    ds_read_b128 v[56:59], v13 offset:64
    s_mov_b64 exec, -1
    ds_read_b128 v[68:71], v124
    ds_read_b128 v[72:75], v125
    ds_read_b128 v[76:79], v126
    ds_read_b128 v[80:83], v127
    s_waitcnt lgkmcnt(12)
    v_mov_b32 v50, v84
    buffer_load_dwordx4 v[16:19], v[50:51], s[36:39], 0 idxen offen sc1
    s_waitcnt lgkmcnt(11)
    v_mov_b32 v50, v85
    buffer_load_dwordx4 v[20:23], v[50:51], s[36:39], 0 idxen offen sc1
    s_waitcnt lgkmcnt(10)
    v_mov_b32 v50, v86
    buffer_load_dwordx4 v[24:27], v[50:51], s[36:39], 0 idxen offen sc1
    s_waitcnt lgkmcnt(9)
    v_mov_b32 v50, v87
    buffer_load_dwordx4 v[28:31], v[50:51], s[36:39], 0 idxen offen sc1
    s_waitcnt lgkmcnt(8)
    v_mov_b32 v50, v88
    buffer_load_dwordx4 v[32:35], v[50:51], s[36:39], 0 idxen offen sc1
    s_waitcnt lgkmcnt(7)
    v_mov_b32 v50, v89
    buffer_load_dwordx4 v[36:39], v[50:51], s[36:39], 0 idxen offen sc1
    s_waitcnt lgkmcnt(6)
    v_mov_b32 v50, v90
    buffer_load_dwordx4 v[40:43], v[50:51], s[36:39], 0 idxen offen sc1
    ds_read_b64 v[116:117], v108
    ds_read_b64 v[118:119], v109
    ds_read_b64 v[120:121], v110
    ds_read_b64 v[122:123], v111
    ds_read_u16 v48, v12 offset:112
    v_mov_b32 v2, 0x3f80
    v_lshlrev_b32 v14, 4, v1
    v_lshlrev_b64 v[14:15], v14, v[2:3]
    s_waitcnt lgkmcnt(1)
    s_nop 0
    v_mfma_f32_4x4x4_16b_bf16 v[92:95], v[14:15], v[68:69], 0
    v_mov_b32 v84, s80
    v_mov_b32 v88, 0
    v_mov_b32 v124, 0x7f800000
    v_mov_b32 v44, 0
    v_mov_b32 v85, s80
    v_mov_b32 v89, 0
    v_mov_b32 v125, 0x7f800000
    v_mov_b32 v45, 0
    v_mov_b32 v86, s80
    v_mov_b32 v90, 0
    v_mov_b32 v126, 0x7f800000
    v_mov_b32 v46, 0
    v_mov_b32 v87, s80
    v_mov_b32 v91, 0
    v_mov_b32 v127, 0x7f800000
    v_mov_b32 v47, 0
    s_waitcnt vmcnt(6)
    v_mfma_f32_16x16x32_bf16 v[60:63], v[52:55], v[4:7], v[92:95]
    v_mfma_f32_16x16x32_bf16 v[60:63], v[8:11], v[16:19], v[60:63]
    s_mov_b64 exec, s[76:77]
    ds_read_b128 v[52:55], v13 offset:128
    s_mov_b64 exec, -1
    s_nop 4
kf_loop:
    s_waitcnt vmcnt(5) lgkmcnt(1)
    v_mfma_f32_16x16x32_bf16 v[64:67], v[56:59], v[4:7], v[92:95]
    v_exp_f32 v60, v60
    v_mfma_f32_16x16x32_bf16 v[64:67], v[8:11], v[20:23], v[64:67]
    v_exp_f32 v61, v61
    v_exp_f32 v62, v62
    v_exp_f32 v63, v63
    ds_read_u16 v50, v12 offset:128
    v_rcp_f32 v124, v124
    v_mfma_f32_4x4x4_16b_bf16 v[108:111], v[2:3], v[2:3], v[60:63]
    v_rcp_f32 v125, v125
    s_mov_b64 exec, s[76:77]
    ds_read_b128 v[56:59], v13 offset:192
    s_mov_b64 exec, -1
    v_rcp_f32 v126, v126
    v_rcp_f32 v127, v127
    s_sub_u32 s86, s86, 1
    v_pk_add_f32 v[84:85], v[84:85], v[124:125]
    v_pk_fma_f32 v[88:89], v[124:125], v[44:45], v[88:89]
    v_pk_add_f32 v[86:87], v[86:87], v[126:127]
    v_pk_fma_f32 v[90:91], v[126:127], v[46:47], v[90:91]
    buffer_load_dwordx4 v[44:47], v[48:49], s[36:39], 0 idxen offen sc1
    s_cbranch_scc1 kf_tr0
kf_r0:
    s_waitcnt vmcnt(5) lgkmcnt(1)
    v_mfma_f32_16x16x32_bf16 v[60:63], v[52:55], v[4:7], v[92:95]
    v_exp_f32 v64, v64
    v_mfma_f32_16x16x32_bf16 v[60:63], v[8:11], v[24:27], v[60:63]
    v_exp_f32 v65, v65
    v_exp_f32 v66, v66
    v_exp_f32 v67, v67
    ds_read_u16 v48, v12 offset:144
    v_rcp_f32 v108, v108
    v_mfma_f32_4x4x4_16b_bf16 v[124:127], v[2:3], v[2:3], v[64:67]
    v_rcp_f32 v109, v109
    s_mov_b64 exec, s[76:77]
    ds_read_b128 v[52:55], v13 offset:256
    s_mov_b64 exec, -1
    v_rcp_f32 v110, v110
    v_rcp_f32 v111, v111
    s_sub_u32 s86, s86, 1
    v_pk_add_f32 v[84:85], v[84:85], v[108:109]
    v_pk_fma_f32 v[88:89], v[108:109], v[16:17], v[88:89]
    v_pk_add_f32 v[86:87], v[86:87], v[110:111]
    v_pk_fma_f32 v[90:91], v[110:111], v[18:19], v[90:91]
    buffer_load_dwordx4 v[16:19], v[50:51], s[36:39], 0 idxen offen sc1
    s_cbranch_scc1 kf_tr1
kf_r1:
    s_waitcnt vmcnt(5) lgkmcnt(1)
    v_mfma_f32_16x16x32_bf16 v[64:67], v[56:59], v[4:7], v[92:95]
    v_exp_f32 v60, v60
    v_mfma_f32_16x16x32_bf16 v[64:67], v[8:11], v[28:31], v[64:67]
    v_exp_f32 v61, v61
    v_exp_f32 v62, v62
    v_exp_f32 v63, v63
    ds_read_u16 v50, v12 offset:160
    v_rcp_f32 v124, v124
    v_mfma_f32_4x4x4_16b_bf16 v[108:111], v[2:3], v[2:3], v[60:63]
    v_rcp_f32 v125, v125
    s_mov_b64 exec, s[76:77]
    ds_read_b128 v[56:59], v13 offset:320
    s_mov_b64 exec, -1
    v_rcp_f32 v126, v126
    v_rcp_f32 v127, v127
    s_sub_u32 s86, s86, 1
    v_pk_add_f32 v[84:85], v[84:85], v[124:125]
    v_pk_fma_f32 v[88:89], v[124:125], v[20:21], v[88:89]
    v_pk_add_f32 v[86:87], v[86:87], v[126:127]
    v_pk_fma_f32 v[90:91], v[126:127], v[22:23], v[90:91]
    buffer_load_dwordx4 v[20:23], v[48:49], s[36:39], 0 idxen offen sc1
    s_cbranch_scc1 kf_tr2
kf_r2:
    s_waitcnt vmcnt(5) lgkmcnt(1)
    v_mfma_f32_16x16x32_bf16 v[60:63], v[52:55], v[4:7], v[92:95]
    v_exp_f32 v64, v64
    v_mfma_f32_16x16x32_bf16 v[60:63], v[8:11], v[32:35], v[60:63]
    v_exp_f32 v65, v65
    v_exp_f32 v66, v66
    v_exp_f32 v67, v67
    ds_read_u16 v48, v12 offset:176
    v_rcp_f32 v108, v108
    v_mfma_f32_4x4x4_16b_bf16 v[124:127], v[2:3], v[2:3], v[64:67]
    v_rcp_f32 v109, v109
    s_mov_b64 exec, s[76:77]
    ds_read_b128 v[52:55], v13 offset:384
    s_mov_b64 exec, -1
    v_rcp_f32 v110, v110
    v_rcp_f32 v111, v111
    s_sub_u32 s86, s86, 1
    v_pk_add_f32 v[84:85], v[84:85], v[108:109]
    v_pk_fma_f32 v[88:89], v[108:109], v[24:25], v[88:89]
    v_pk_add_f32 v[86:87], v[86:87], v[110:111]
    v_pk_fma_f32 v[90:91], v[110:111], v[26:27], v[90:91]
    buffer_load_dwordx4 v[24:27], v[50:51], s[36:39], 0 idxen offen sc1
    s_cbranch_scc1 kf_tr3
kf_r3:
    s_sub_i32 s92, s92, 4
    s_cmp_lt_i32 s92, 0
    s_cbranch_scc1 kf_pr3
kf_q3:
    s_waitcnt vmcnt(5) lgkmcnt(1)
    v_mfma_f32_16x16x32_bf16 v[64:67], v[56:59], v[4:7], v[92:95]
    v_exp_f32 v60, v60
    v_mfma_f32_16x16x32_bf16 v[64:67], v[8:11], v[36:39], v[64:67]
    v_exp_f32 v61, v61
    v_exp_f32 v62, v62
    v_exp_f32 v63, v63
    ds_read_u16 v50, v12 offset:192
    v_rcp_f32 v124, v124
    v_mfma_f32_4x4x4_16b_bf16 v[108:111], v[2:3], v[2:3], v[60:63]
    v_rcp_f32 v125, v125
    s_mov_b64 exec, s[76:77]
    ds_read_b128 v[56:59], v13 offset:448
    s_mov_b64 exec, -1
    v_rcp_f32 v126, v126
    v_rcp_f32 v127, v127
    s_sub_u32 s86, s86, 1
    v_pk_add_f32 v[84:85], v[84:85], v[124:125]
    v_pk_fma_f32 v[88:89], v[124:125], v[28:29], v[88:89]
    v_pk_add_f32 v[86:87], v[86:87], v[126:127]
    v_pk_fma_f32 v[90:91], v[126:127], v[30:31], v[90:91]
    buffer_load_dwordx4 v[28:31], v[48:49], s[36:39], 0 idxen offen sc1
    s_cbranch_scc1 kf_tr4
kf_r4:
    s_waitcnt vmcnt(5) lgkmcnt(1)
    v_mfma_f32_16x16x32_bf16 v[60:63], v[52:55], v[4:7], v[92:95]
    v_exp_f32 v64, v64
    v_mfma_f32_16x16x32_bf16 v[60:63], v[8:11], v[40:43], v[60:63]
    v_exp_f32 v65, v65
    v_exp_f32 v66, v66
    v_exp_f32 v67, v67
    ds_read_u16 v48, v12 offset:208
    v_rcp_f32 v108, v108
    v_mfma_f32_4x4x4_16b_bf16 v[124:127], v[2:3], v[2:3], v[64:67]
    v_rcp_f32 v109, v109
    s_mov_b64 exec, s[76:77]
    ds_read_b128 v[52:55], v13 offset:512
    s_mov_b64 exec, -1
    v_rcp_f32 v110, v110
    v_rcp_f32 v111, v111
    s_sub_u32 s86, s86, 1
    v_pk_add_f32 v[84:85], v[84:85], v[108:109]
    v_pk_fma_f32 v[88:89], v[108:109], v[32:33], v[88:89]
    v_pk_add_f32 v[86:87], v[86:87], v[110:111]
    v_pk_fma_f32 v[90:91], v[110:111], v[34:35], v[90:91]
    buffer_load_dwordx4 v[32:35], v[50:51], s[36:39], 0 idxen offen sc1
    s_cbranch_scc1 kf_tr5
kf_r5:
    s_waitcnt vmcnt(5) lgkmcnt(1)
    v_mfma_f32_16x16x32_bf16 v[64:67], v[56:59], v[4:7], v[92:95]
    v_exp_f32 v60, v60
    v_mfma_f32_16x16x32_bf16 v[64:67], v[8:11], v[44:47], v[64:67]
    v_exp_f32 v61, v61
    v_exp_f32 v62, v62
    v_exp_f32 v63, v63
    ds_read_u16 v50, v12 offset:224
    v_rcp_f32 v124, v124
    v_mfma_f32_4x4x4_16b_bf16 v[108:111], v[2:3], v[2:3], v[60:63]
    v_rcp_f32 v125, v125
    s_mov_b64 exec, s[76:77]
    ds_read_b128 v[56:59], v13 offset:576
    s_mov_b64 exec, -1
    v_rcp_f32 v126, v126
    v_rcp_f32 v127, v127
    s_sub_u32 s86, s86, 1
    v_pk_add_f32 v[84:85], v[84:85], v[124:125]
    v_pk_fma_f32 v[88:89], v[124:125], v[36:37], v[88:89]
    v_pk_add_f32 v[86:87], v[86:87], v[126:127]
    v_pk_fma_f32 v[90:91], v[126:127], v[38:39], v[90:91]
    buffer_load_dwordx4 v[36:39], v[48:49], s[36:39], 0 idxen offen sc1
    s_cbranch_scc1 kf_tr6
kf_r6:
    s_waitcnt vmcnt(5) lgkmcnt(1)
    v_mfma_f32_16x16x32_bf16 v[60:63], v[52:55], v[4:7], v[92:95]
    v_exp_f32 v64, v64
    v_mfma_f32_16x16x32_bf16 v[60:63], v[8:11], v[16:19], v[60:63]
    v_exp_f32 v65, v65
    v_exp_f32 v66, v66
    v_exp_f32 v67, v67
    ds_read_u16 v48, v12 offset:240
    v_rcp_f32 v108, v108
    v_mfma_f32_4x4x4_16b_bf16 v[124:127], v[2:3], v[2:3], v[64:67]
    v_rcp_f32 v109, v109
    s_mov_b64 exec, s[76:77]
    ds_read_b128 v[52:55], v13 offset:640
    s_mov_b64 exec, -1
    v_rcp_f32 v110, v110
    v_rcp_f32 v111, v111
    v_add_u32 v12, 128, v12
    v_add_u32 v13, 512, v13
    s_sub_u32 s86, s86, 1
    v_pk_add_f32 v[84:85], v[84:85], v[108:109]
    v_pk_fma_f32 v[88:89], v[108:109], v[40:41], v[88:89]
    v_pk_add_f32 v[86:87], v[86:87], v[110:111]
    v_pk_fma_f32 v[90:91], v[110:111], v[42:43], v[90:91]
    buffer_load_dwordx4 v[40:43], v[50:51], s[36:39], 0 idxen offen sc1
    s_cbranch_scc1 kf_tr7
kf_r7:
    s_sub_i32 s92, s92, 4
    s_cmp_lt_i32 s92, 0
    s_cbranch_scc1 kf_pr7
kf_q7:
    s_branch kf_loop
kf_tr0:
    s_swappc_b64 s[82:83], s[84:85]
    s_branch kf_r0
    v_rcp_f32 v108, v108
    v_rcp_f32 v109, v109
    v_rcp_f32 v110, v110
    v_rcp_f32 v111, v111
    v_pk_add_f32 v[84:85], v[84:85], v[108:109]
    v_pk_fma_f32 v[88:89], v[108:109], v[16:17], v[88:89]
    v_pk_add_f32 v[86:87], v[86:87], v[110:111]
    v_pk_fma_f32 v[90:91], v[110:111], v[18:19], v[90:91]
    s_setpc_b64 s[84:85]
kf_tr1:
    s_swappc_b64 s[82:83], s[84:85]
    s_branch kf_r1
    v_rcp_f32 v124, v124
    v_rcp_f32 v125, v125
    v_rcp_f32 v126, v126
    v_rcp_f32 v127, v127
    v_pk_add_f32 v[84:85], v[84:85], v[124:125]
    v_pk_fma_f32 v[88:89], v[124:125], v[20:21], v[88:89]
    v_pk_add_f32 v[86:87], v[86:87], v[126:127]
    v_pk_fma_f32 v[90:91], v[126:127], v[22:23], v[90:91]
    s_setpc_b64 s[84:85]
kf_tr2:
    s_swappc_b64 s[82:83], s[84:85]
    s_branch kf_r2
    v_rcp_f32 v108, v108
    v_rcp_f32 v109, v109
    v_rcp_f32 v110, v110
    v_rcp_f32 v111, v111
    v_pk_add_f32 v[84:85], v[84:85], v[108:109]
    v_pk_fma_f32 v[88:89], v[108:109], v[24:25], v[88:89]
    v_pk_add_f32 v[86:87], v[86:87], v[110:111]
    v_pk_fma_f32 v[90:91], v[110:111], v[26:27], v[90:91]
    s_setpc_b64 s[84:85]
kf_tr3:
    s_swappc_b64 s[82:83], s[84:85]
    s_branch kf_r3
    v_rcp_f32 v124, v124
    v_rcp_f32 v125, v125
    v_rcp_f32 v126, v126
    v_rcp_f32 v127, v127
    v_pk_add_f32 v[84:85], v[84:85], v[124:125]
    v_pk_fma_f32 v[88:89], v[124:125], v[28:29], v[88:89]
    v_pk_add_f32 v[86:87], v[86:87], v[126:127]
    v_pk_fma_f32 v[90:91], v[126:127], v[30:31], v[90:91]
    s_setpc_b64 s[84:85]
kf_pr3:
    s_sub_u32 s93, s93, 1
    s_cbranch_scc1 kf_pr3c
    s_cmp_eq_u32 s93, 0
    s_cbranch_scc1 kf_pr3b
    s_setprio 2
    s_add_i32 s92, s92, 14
    s_branch kf_q3
kf_pr3b:
    s_setprio 1
    s_add_i32 s92, s92, 10
    s_branch kf_q3
kf_pr3c:
    s_setprio 0
    s_mov_b32 s92, 0x7fffffff
    s_branch kf_q3
kf_tr4:
    s_swappc_b64 s[82:83], s[84:85]
    s_branch kf_r4
    v_rcp_f32 v108, v108
    v_rcp_f32 v109, v109
    v_rcp_f32 v110, v110
    v_rcp_f32 v111, v111
    v_pk_add_f32 v[84:85], v[84:85], v[108:109]
    v_pk_fma_f32 v[88:89], v[108:109], v[32:33], v[88:89]
    v_pk_add_f32 v[86:87], v[86:87], v[110:111]
    v_pk_fma_f32 v[90:91], v[110:111], v[34:35], v[90:91]
    s_setpc_b64 s[84:85]
kf_tr5:
    s_swappc_b64 s[82:83], s[84:85]
    s_branch kf_r5
    v_rcp_f32 v124, v124
    v_rcp_f32 v125, v125
    v_rcp_f32 v126, v126
    v_rcp_f32 v127, v127
    v_pk_add_f32 v[84:85], v[84:85], v[124:125]
    v_pk_fma_f32 v[88:89], v[124:125], v[36:37], v[88:89]
    v_pk_add_f32 v[86:87], v[86:87], v[126:127]
    v_pk_fma_f32 v[90:91], v[126:127], v[38:39], v[90:91]
    s_setpc_b64 s[84:85]
kf_tr6:
    s_swappc_b64 s[82:83], s[84:85]
    s_branch kf_r6
    v_rcp_f32 v108, v108
    v_rcp_f32 v109, v109
    v_rcp_f32 v110, v110
    v_rcp_f32 v111, v111
    v_pk_add_f32 v[84:85], v[84:85], v[108:109]
    v_pk_fma_f32 v[88:89], v[108:109], v[40:41], v[88:89]
    v_pk_add_f32 v[86:87], v[86:87], v[110:111]
    v_pk_fma_f32 v[90:91], v[110:111], v[42:43], v[90:91]
    s_setpc_b64 s[84:85]
kf_tr7:
    s_swappc_b64 s[82:83], s[84:85]
    s_branch kf_r7
    v_rcp_f32 v124, v124
    v_rcp_f32 v125, v125
    v_rcp_f32 v126, v126
    v_rcp_f32 v127, v127
    v_pk_add_f32 v[84:85], v[84:85], v[124:125]
    v_pk_fma_f32 v[88:89], v[124:125], v[44:45], v[88:89]
    v_pk_add_f32 v[86:87], v[86:87], v[126:127]
    v_pk_fma_f32 v[90:91], v[126:127], v[46:47], v[90:91]
    s_setpc_b64 s[84:85]
kf_pr7:
    s_sub_u32 s93, s93, 1
    s_cbranch_scc1 kf_pr7c
    s_cmp_eq_u32 s93, 0
    s_cbranch_scc1 kf_pr7b
    s_setprio 2
    s_add_i32 s92, s92, 14
    s_branch kf_q7
kf_pr7b:
    s_setprio 1
    s_add_i32 s92, s92, 10
    s_branch kf_q7
kf_pr7c:
    s_setprio 0
    s_mov_b32 s92, 0x7fffffff
    s_branch kf_q7
kf_evA0:
    v_mfma_f32_4x4x4_16b_bf16 v[92:95], v[14:15], v[72:73], 0
    s_mov_b32 s86, 1
    s_add_u32 s84, s84, kf_evB0-kf_evA0
    s_addc_u32 s85, s85, 0
    s_cmp_eq_u32 s73, 0
    s_cbranch_scc1 kf_evA0x
    v_mov_b64 v[4:5], v[104:105]
    v_mov_b64 v[6:7], v[106:107]
kf_evA0x:
    s_setpc_b64 s[82:83]
kf_evB0:
    v_mfma_f32_4x4x4_16b_bf16 v[98:101], v[14:15], v[70:71], 0
    v_rcp_f32 v84, v84
    v_rcp_f32 v85, v85
    v_rcp_f32 v86, v86
    v_rcp_f32 v87, v87
    s_nop 0
    v_pk_fma_f32 v[88:89], v[88:89], v[84:85], v[98:99]
    v_pk_fma_f32 v[90:91], v[90:91], v[86:87], v[100:101]
    v_max_f32 v88, 0, v88
    v_max_f32 v89, 0, v89
    v_max_f32 v90, 0, v90
    v_max_f32 v91, 0, v91
    v_mov_b64 v[84:85], s[80:81]
    v_mov_b64 v[86:87], s[80:81]
    v_mfma_f32_4x4x4_16b_bf16 v[98:101], v[14:15], v[116:117], v[88:91]
    s_sub_u32 s86, s88, 3
    s_add_u32 s84, s84, kf_evA1-kf_evB0
    s_addc_u32 s85, s85, 0
    v_mov_b64 v[88:89], 0
    v_mov_b64 v[90:91], 0
    v_cvt_pk_bf16_f32 v102, v98, v99
    v_cvt_pk_bf16_f32 v103, v100, v101
    buffer_store_dwordx2 v[102:103], v112, s[44:47], s31 offen
    s_setpc_b64 s[82:83]
kf_evA1:
    v_mfma_f32_4x4x4_16b_bf16 v[92:95], v[14:15], v[76:77], 0
    s_mov_b32 s86, 1
    s_add_u32 s84, s84, kf_evB1-kf_evA1
    s_addc_u32 s85, s85, 0
    s_cmp_eq_u32 s74, 0
    s_cbranch_scc1 kf_evA1x
    v_mov_b64 v[4:5], v[104:105]
    v_mov_b64 v[6:7], v[106:107]
kf_evA1x:
    s_setpc_b64 s[82:83]
kf_evB1:
    v_mfma_f32_4x4x4_16b_bf16 v[98:101], v[14:15], v[74:75], 0
    v_rcp_f32 v84, v84
    v_rcp_f32 v85, v85
    v_rcp_f32 v86, v86
    v_rcp_f32 v87, v87
    s_nop 0
    v_pk_fma_f32 v[88:89], v[88:89], v[84:85], v[98:99]
    v_pk_fma_f32 v[90:91], v[90:91], v[86:87], v[100:101]
    v_max_f32 v88, 0, v88
    v_max_f32 v89, 0, v89
    v_max_f32 v90, 0, v90
    v_max_f32 v91, 0, v91
    v_mov_b64 v[84:85], s[80:81]
    v_mov_b64 v[86:87], s[80:81]
    v_mfma_f32_4x4x4_16b_bf16 v[98:101], v[14:15], v[118:119], v[88:91]
    s_sub_u32 s86, s89, 3
    s_add_u32 s84, s84, kf_evA2-kf_evB1
    s_addc_u32 s85, s85, 0
    v_mov_b64 v[88:89], 0
    v_mov_b64 v[90:91], 0
    v_cvt_pk_bf16_f32 v102, v98, v99
    v_cvt_pk_bf16_f32 v103, v100, v101
    buffer_store_dwordx2 v[102:103], v113, s[44:47], s31 offen
    s_setpc_b64 s[82:83]
kf_evA2:
    v_mfma_f32_4x4x4_16b_bf16 v[92:95], v[14:15], v[80:81], 0
    s_min_u32 s86, s90, 1
    s_cmp_eq_u32 s90, 0
    s_mov_b32 s95, kf_evB2-kf_evA2
    s_cmov_b32 s95, kf_evF2-kf_evA2
    s_add_u32 s84, s84, s95
    s_addc_u32 s85, s85, 0
    s_setpc_b64 s[82:83]
kf_evF2:
    s_add_u32 s84, s84, kf_evB2-kf_evF2
    s_addc_u32 s85, s85, 0
    s_add_u32 s82, s82, 4
    s_addc_u32 s83, s83, 0
    s_setpc_b64 s[82:83]
kf_evB2:
    v_mfma_f32_4x4x4_16b_bf16 v[98:101], v[14:15], v[78:79], 0
    v_rcp_f32 v84, v84
    v_rcp_f32 v85, v85
    v_rcp_f32 v86, v86
    v_rcp_f32 v87, v87
    s_nop 0
    v_pk_fma_f32 v[88:89], v[88:89], v[84:85], v[98:99]
    v_pk_fma_f32 v[90:91], v[90:91], v[86:87], v[100:101]
    v_max_f32 v88, 0, v88
    v_max_f32 v89, 0, v89
    v_max_f32 v90, 0, v90
    v_max_f32 v91, 0, v91
    v_mov_b64 v[84:85], s[80:81]
    v_mov_b64 v[86:87], s[80:81]
    v_mfma_f32_4x4x4_16b_bf16 v[98:101], v[14:15], v[120:121], v[88:91]
    s_sub_u32 s86, s90, 2
    s_add_u32 s84, s84, kf_evF3-kf_evB2
    s_addc_u32 s85, s85, 0
    v_mov_b64 v[88:89], 0
    v_mov_b64 v[90:91], 0
    v_cvt_pk_bf16_f32 v102, v98, v99
    v_cvt_pk_bf16_f32 v103, v100, v101
    buffer_store_dwordx2 v[102:103], v114, s[44:47], s31 offen
    s_cmp_eq_u32 s90, 0
    s_cbranch_scc1 kf_done
    s_setpc_b64 s[82:83]
kf_evF3:
    s_add_u32 s84, s84, kf_evB3-kf_evF3
    s_addc_u32 s85, s85, 0
    s_add_u32 s82, s82, 4
    s_addc_u32 s83, s83, 0
    s_setpc_b64 s[82:83]
kf_evB3:
    v_mfma_f32_4x4x4_16b_bf16 v[98:101], v[14:15], v[82:83], 0
    v_rcp_f32 v84, v84
    v_rcp_f32 v85, v85
    v_rcp_f32 v86, v86
    v_rcp_f32 v87, v87
    s_nop 0
    v_pk_fma_f32 v[88:89], v[88:89], v[84:85], v[98:99]
    v_pk_fma_f32 v[90:91], v[90:91], v[86:87], v[100:101]
    v_max_f32 v88, 0, v88
    v_max_f32 v89, 0, v89
    v_max_f32 v90, 0, v90
    v_max_f32 v91, 0, v91
    s_nop 1
    v_mfma_f32_4x4x4_16b_bf16 v[98:101], v[14:15], v[122:123], v[88:91]
    s_nop 4
    v_cvt_pk_bf16_f32 v102, v98, v99
    v_cvt_pk_bf16_f32 v103, v100, v101
    buffer_store_dwordx2 v[102:103], v115, s[44:47], s31 offen
kf_done:
kf_exit:
    s_endpgm
kf_slow:
    s_mov_b32 s48, s16
    s_and_b32 s49, s17, 0xffff
    s_mov_b32 s50, 1024
    s_mov_b32 s51, 0x00020000
    s_mov_b32 s40, s4
    s_and_b32 s41, s5, 0xffff
    s_mov_b32 s42, 6400000
    s_mov_b32 s43, 0x00020000
    s_setprio 0
    s_waitcnt vmcnt(0)
    v_and_b32 v4, 7, v0
    v_lshlrev_b32 v108, 4, v4
    v_lshlrev_b32 v109, 3, v4
    v_lshlrev_b32 v105, 4, v0
    v_add_u32 v105, 7168, v105
    s_mov_b32 s93, 0
    s_mov_b32 s95, 87040
kf_s_slice:
    v_mov_b32 v8, 0
    v_mov_b32 v9, 0
    v_mov_b32 v10, 0
    v_mov_b32 v11, 0
    ds_write_b128 v105, v[8:11] offset:0
    ds_write_b128 v105, v[8:11] offset:16384
    ds_write_b128 v105, v[8:11] offset:32768
    ds_write_b128 v105, v[8:11] offset:49152
    buffer_load_dwordx2 v[32:33], v109, s[48:51], s94 offen offset:0
    buffer_load_dwordx2 v[34:35], v109, s[48:51], s94 offen offset:256
    buffer_load_dwordx2 v[36:37], v109, s[48:51], s94 offen offset:512
    buffer_load_dwordx2 v[38:39], v109, s[48:51], s94 offen offset:768
    s_mov_b32 s60, 0xbfb8aa3b
    s_waitcnt vmcnt(0)
    v_lshlrev_b32 v16, 16, v32
    v_and_b32 v17, 0xffff0000, v32
    v_lshlrev_b32 v18, 16, v33
    v_and_b32 v19, 0xffff0000, v33
    v_lshlrev_b32 v20, 16, v34
    v_and_b32 v21, 0xffff0000, v34
    v_lshlrev_b32 v22, 16, v35
    v_and_b32 v23, 0xffff0000, v35
    v_lshlrev_b32 v24, 16, v36
    v_and_b32 v25, 0xffff0000, v36
    v_lshlrev_b32 v26, 16, v37
    v_and_b32 v27, 0xffff0000, v37
    v_lshlrev_b32 v28, 16, v38
    v_and_b32 v29, 0xffff0000, v38
    v_lshlrev_b32 v30, 16, v39
    v_and_b32 v31, 0xffff0000, v39
    v_mul_f32 v16, s60, v16
    v_mul_f32 v17, s60, v17
    v_mul_f32 v18, s60, v18
    v_mul_f32 v19, s60, v19
    v_mul_f32 v20, s60, v20
    v_mul_f32 v21, s60, v21
    v_mul_f32 v22, s60, v22
    v_mul_f32 v23, s60, v23
    v_mul_f32 v24, s60, v24
    v_mul_f32 v25, s60, v25
    v_mul_f32 v26, s60, v26
    v_mul_f32 v27, s60, v27
    v_mul_f32 v28, s60, v28
    v_mul_f32 v29, s60, v29
    v_mul_f32 v30, s60, v30
    v_mul_f32 v31, s60, v31
    v_lshrrev_b32 v2, 3, v1
    v_mov_b32 v41, v108
    s_lshl_b32 s61, s29, 10
    s_add_u32 s61, s61, 17666048
    s_mov_b32 s62, s3
    s_waitcnt lgkmcnt(0)
    s_barrier
kf_s_chunk:
    s_and_b32 s63, s62, 7
    s_lshl_b32 s63, s63, 5
    s_lshr_b32 s64, s62, 3
    s_add_u32 s63, s63, s64
    s_lshl_b32 s63, s63, 2
    v_mov_b32 v32, s63
    buffer_load_dword v32, v32, s[32:35], s61 offen sc1
    s_mul_i32 s64, s62, 18816
    s_add_u32 s64, s64, 12849152
    s_add_u32 s65, s64, 6256
    s_waitcnt vmcnt(0)
    v_readfirstlane_b32 s66, v32
    s_bfe_u32 s67, s66, 0xf0010
    s_and_b32 s66, s66, 0xffff
    s_add_u32 s67, s67, s66
kf_s_step:
    s_cmp_ge_u32 s66, s67
    s_cbranch_scc1 kf_s_next
    v_add_u32 v32, s66, v2
    v_cmp_gt_u32 vcc, s67, v32
    s_mov_b64 exec, vcc
    v_lshlrev_b32 v33, 2, v32
    v_lshlrev_b32 v34, 3, v32
    buffer_load_dword v35, v33, s[32:35], s64 offen sc1
    buffer_load_dwordx2 v[36:37], v34, s[32:35], s65 offen sc1
    s_waitcnt vmcnt(0)
    v_and_b32 v40, 0xffff, v35
    v_add_u32 v40, s93, v40
    v_lshrrev_b32 v35, 16, v35
    v_and_b32 v33, 28, v35
    v_lshlrev_b32 v33, 2, v33
    v_xor_b32 v33, v33, v108
    v_lshl_add_u32 v33, v35, 5, v33
    v_add_u32 v33, s95, v33
    buffer_load_dwordx4 v[44:47], v[40:41], s[36:39], 0 idxen offen sc1
    ds_read_b128 v[48:51], v33
    v_lshlrev_b32 v52, 16, v36
    v_and_b32 v53, 0xffff0000, v36
    v_lshlrev_b32 v54, 16, v37
    v_and_b32 v55, 0xffff0000, v37
    v_lshl_add_u32 v34, v35, 6, v108
    s_waitcnt vmcnt(0) lgkmcnt(0)
    v_lshlrev_b32 v56, 16, v44
    v_lshlrev_b32 v60, 16, v48
    v_add_f32 v56, v56, v60
    v_fmac_f32 v56, v52, v16
    v_fmac_f32 v56, v53, v20
    v_fmac_f32 v56, v54, v24
    v_fmac_f32 v56, v55, v28
    v_exp_f32 v56, v56
    s_nop 0
    v_add_f32 v56, 1.0, v56
    v_rcp_f32 v56, v56
    s_nop 0
    v_mul_f32 v44, v56, v44
    ds_add_f32 v34, v56 offset:7168
    ds_add_f32 v34, v44 offset:7296
    v_lshlrev_b32 v57, 16, v45
    v_and_b32 v60, 0xffff0000, v48
    v_add_f32 v57, v57, v60
    v_fmac_f32 v57, v52, v17
    v_fmac_f32 v57, v53, v21
    v_fmac_f32 v57, v54, v25
    v_fmac_f32 v57, v55, v29
    v_exp_f32 v57, v57
    s_nop 0
    v_add_f32 v57, 1.0, v57
    v_rcp_f32 v57, v57
    s_nop 0
    v_mul_f32 v45, v57, v45
    ds_add_f32 v34, v57 offset:7172
    ds_add_f32 v34, v45 offset:7300
    v_lshlrev_b32 v58, 16, v46
    v_lshlrev_b32 v60, 16, v49
    v_add_f32 v58, v58, v60
    v_fmac_f32 v58, v52, v18
    v_fmac_f32 v58, v53, v22
    v_fmac_f32 v58, v54, v26
    v_fmac_f32 v58, v55, v30
    v_exp_f32 v58, v58
    s_nop 0
    v_add_f32 v58, 1.0, v58
    v_rcp_f32 v58, v58
    s_nop 0
    v_mul_f32 v46, v58, v46
    ds_add_f32 v34, v58 offset:7176
    ds_add_f32 v34, v46 offset:7304
    v_lshlrev_b32 v59, 16, v47
    v_and_b32 v60, 0xffff0000, v49
    v_add_f32 v59, v59, v60
    v_fmac_f32 v59, v52, v19
    v_fmac_f32 v59, v53, v23
    v_fmac_f32 v59, v54, v27
    v_fmac_f32 v59, v55, v31
    v_exp_f32 v59, v59
    s_nop 0
    v_add_f32 v59, 1.0, v59
    v_rcp_f32 v59, v59
    s_nop 0
    v_mul_f32 v47, v59, v47
    ds_add_f32 v34, v59 offset:7180
    ds_add_f32 v34, v47 offset:7308
    s_mov_b64 exec, -1
    s_add_u32 s66, s66, 8
    s_branch kf_s_step
kf_s_next:
    s_add_u32 s62, s62, 16
    s_cmp_lt_u32 s62, 256
    s_cbranch_scc1 kf_s_chunk
    s_waitcnt lgkmcnt(0)
    s_barrier
    s_mov_b32 s62, 0
    v_lshrrev_b32 v2, 3, v0
kf_s_fin:
    v_add_u32 v32, s62, v2
    v_cmp_gt_u32 vcc, 196, v32
    s_mov_b64 exec, vcc
    s_cbranch_execz kf_s_end
    v_xor_b32 v33, v32, v4
    v_and_b32 v33, 7, v33
    v_lshl_add_u32 v33, v33, 4, s95
    v_lshl_add_u32 v33, v32, 7, v33
    v_lshl_add_u32 v34, v32, 8, v108
    v_lshl_add_u32 v35, v32, 8, v109
    ds_read_b128 v[44:47], v33
    buffer_load_dwordx2 v[48:49], v35, s[40:43], s31 offen
    ds_read_b128 v[52:55], v34 offset:7168
    ds_read_b128 v[56:59], v34 offset:7296
    s_waitcnt vmcnt(0) lgkmcnt(0)
    v_pk_add_f32 v[52:53], v[52:53], s[80:81]
    v_pk_add_f32 v[54:55], v[54:55], s[80:81]
    v_rcp_f32 v52, v52
    v_rcp_f32 v53, v53
    v_rcp_f32 v54, v54
    v_rcp_f32 v55, v55
    v_lshlrev_b32 v98, 16, v46
    v_and_b32 v99, 0xffff0000, v46
    v_lshlrev_b32 v100, 16, v47
    v_and_b32 v101, 0xffff0000, v47
    v_pk_fma_f32 v[56:57], v[56:57], v[52:53], v[98:99]
    v_pk_fma_f32 v[58:59], v[58:59], v[54:55], v[100:101]
    v_lshlrev_b32 v98, 16, v48
    v_and_b32 v99, 0xffff0000, v48
    v_lshlrev_b32 v100, 16, v49
    v_and_b32 v101, 0xffff0000, v49
    v_max_f32 v56, 0, v56
    v_max_f32 v57, 0, v57
    v_max_f32 v58, 0, v58
    v_max_f32 v59, 0, v59
    v_pk_add_f32 v[56:57], v[56:57], v[98:99]
    v_pk_add_f32 v[58:59], v[58:59], v[100:101]
    v_cvt_pk_bf16_f32 v102, v56, v57
    v_cvt_pk_bf16_f32 v103, v58, v59
    buffer_store_dwordx2 v[102:103], v35, s[44:47], s31 offen
    s_add_u32 s62, s62, 128
    s_branch kf_s_fin
kf_s_end:
    s_mov_b64 exec, -1
    s_cmp_lg_u32 s93, 0
    s_cbranch_scc1 kf_exit
    s_movk_i32 s93, 25096
    s_add_u32 s95, s95, 25600
    s_add_u32 s94, s94, 64
    s_add_u32 s31, s31, 64
    s_barrier
    s_branch kf_s_slice
.section .rodata,"a"
.p2align 6
.amdhsa_kernel kf_kernel
  .amdhsa_next_free_vgpr 128
  .amdhsa_next_free_sgpr 102
  .amdhsa_accum_offset 128
  .amdhsa_group_segment_fixed_size 0
  .amdhsa_kernarg_size 96
  .amdhsa_user_sgpr_count 2
  .amdhsa_user_sgpr_kernarg_segment_ptr 1
  .amdhsa_system_sgpr_workgroup_id_x 1
.end_amdhsa_kernel
```
